```python
import torch

def _softmax(x, axis=-1):
    return torch.softmax(x, dim=axis)
def _gelu(x):
    return torch.nn.functional.gelu(x, approximate="tanh")
def _silu(x):
    return torch.nn.functional.silu(x)
def _sigmoid(x):
    return torch.sigmoid(x)
def _layernorm(x, axis=-1, eps=1e-5):
    m = x.mean(dim=axis, keepdim=True)
    v = x.var(dim=axis, keepdim=True, unbiased=False)
    return (x - m) / torch.sqrt(v + eps)
def _scatter_add(tgt, idx, src, axis=0):
    return tgt.clone().index_add_(axis, idx, src)
def _segment_sum(src, seg, n):
    out = torch.zeros((n,) + src.shape[1:], dtype=src.dtype)
    return out.index_add_(0, seg, src)
def _pad(x, pw):
    flat = tuple(v for pair in reversed(pw) for v in pair)
    return torch.nn.functional.pad(x, flat)

kernel_name = 'gated_mix__grouped_kv_mqa__glu_gated_bilinear__prompt'

def setup_inputs():

    _w = (lambda a: (lambda t: t.to(torch.bfloat16) if t.is_floating_point() else t)(torch.as_tensor(a)))
    def _A_setup():
        B, S, D, H = 1, 2048, 448, 16
        Dh = D // H
        return {
            "x": _w((lambda *s: torch.randn(*s, dtype=torch.bfloat16) * 0.05)(B, S, D)),
            "wq": _w((lambda *s: torch.randn(*s, dtype=torch.bfloat16) * 0.8)(D, H * Dh)),
            "wk": _w((lambda *s: torch.randn(*s, dtype=torch.bfloat16) * 0.8)(D, Dh)),
            "wv": _w((lambda *s: torch.randn(*s, dtype=torch.bfloat16) * 0.05)(D, Dh)),
            "wo": _w((lambda *s: torch.randn(*s, dtype=torch.bfloat16) * 0.05)(H * Dh, D)),
        }
    _A_in = _A_setup()

    def _B_setup():
        B, S, D, F = 1, 2048, 448, 1792
        return {
            "x": _w((lambda *s: torch.randn(*s, dtype=torch.bfloat16) * 0.05)(B, S, D)),
            "w_gate": _w((lambda *s: torch.randn(*s, dtype=torch.bfloat16) * 0.8)(D, F) * (D ** -0.5)),
            "w_up": _w((lambda *s: torch.randn(*s, dtype=torch.bfloat16) * 0.8)(D, F) * (D ** -0.5)),
            "w_down": _w((lambda *s: torch.randn(*s, dtype=torch.bfloat16) * 0.8)(F, D) * (F ** -0.5)),
        }
    _B_in = _B_setup()

    return {
        "A_x": _A_in["x"],
        "A_wq": _A_in["wq"],
        "A_wk": _A_in["wk"],
        "A_wv": _A_in["wv"],
        "A_wo": _A_in["wo"],
        "B_x": _B_in["x"],
        "B_w_gate": _B_in["w_gate"],
        "B_w_up": _B_in["w_up"],
        "B_w_down": _B_in["w_down"],
        "gate_w": _w((lambda *s: torch.randn(*s, dtype=torch.bfloat16) * 0.05)(448) * 16.0),
    }

def reference(A_x, A_wq, A_wk, A_wv, A_wo, B_x, B_w_gate, B_w_up, B_w_down, gate_w):
    def _A_ref(x, wq, wk, wv, wo):
        B, S, D = x.shape
        H = 16
        Dh = D // H
        q = (lambda x, *d: x.permute(*d))((x @ wq).reshape(B, S, H, Dh), 0, 2, 1, 3)
        k = x @ wk
        v = x @ wv
        scores = torch.einsum("bhqd,bkd->bhqk", q, k) * (Dh ** -0.5)
        p = _softmax(scores, axis=-1)
        o = torch.einsum("bhqk,bkd->bhqd", p, v)
        return (lambda x, *d: x.permute(*d))(o, 0, 2, 1, 3).reshape(B, S, H * Dh) @ wo

    def _B_ref(x, w_gate, w_up, w_down):
        g = torch.einsum("bsd,df->bsf", x, w_gate)
        u = torch.einsum("bsd,df->bsf", x, w_up)
        h = g * u
        return torch.einsum("bsf,fd->bsd", h, w_down)

    x = A_x
    g = _sigmoid((x * gate_w).sum(-1, keepdims=True))
    a = _A_ref(x, A_wq, A_wk, A_wv, A_wo)
    b = _B_ref(x, B_w_gate, B_w_up, B_w_down)
    return g * a + (1 - g) * b
```

```asm
; @launch grid=(256,1,1) block=(512,1,1) lds=160000
.amdgcn_target "amdgcn-amd-amdhsa--gfx950"
.text
.globl gated_mix__grouped_kv_mqa__glu_gated_bilinear__prompt_kernel
.p2align 8
.type gated_mix__grouped_kv_mqa__glu_gated_bilinear__prompt_kernel,@function
gated_mix__grouped_kv_mqa__glu_gated_bilinear__prompt_kernel:
    s_cmp_ge_u32 s2, 256
    s_cbranch_scc1 EXIT
    s_load_dwordx16 s[4:19], s[0:1], 0
    s_load_dwordx8 s[20:27], s[0:1], 64
    s_load_dwordx2 s[28:29], s[0:1], 96
    v_lshrrev_b32 v1, 6, v0
    v_and_b32 v0, 63, v0
    v_readfirstlane_b32 s67, v1
    v_lshlrev_b32 v1, 4, v0
    s_and_b32 s68, s2, 7
    s_lshr_b32 s69, s2, 3
    s_and_b32 s70, s69, 3
    s_lshr_b32 s71, s68, 1
    s_lshl_b32 s71, s71, 2
    s_add_u32 s60, s71, s70
    s_lshr_b32 s63, s69, 2
    s_sub_u32 s65, s63, 1
    s_and_b32 s64, s68, 1
    s_mul_i32 s71, s64, 7
    s_add_u32 s61, s71, s65
    s_add_u32 s70, s64, 14
    s_cmp_eq_u32 s63, 0
    s_cselect_b32 s61, s70, s61
    s_lshl_b32 s30, s60, 1
    s_add_u32 s30, s30, s64
    s_sub_u32 s31, s2, 32
    s_and_b32 s62, s67, 3
    s_cmp_lt_u32 s67, 4
    s_cbranch_scc1 AW
    v_lshrrev_b32 v23, 3, v0
    v_lshrrev_b32 v24, 4, v0
    v_and_b32 v25, 7, v0
    v_xor_b32 v25, v25, v24
    s_lshl_b32 s67, s60, 7
    s_lshl_b32 s68, s62, 5
    s_add_u32 s67, s67, s68
    v_add_u32 v26, s67, v23
    v_mul_u32_u24 v26, 896, v26
    v_lshl_add_u32 v2, v25, 4, v26
    v_xor_b32 v27, 4, v25
    v_lshl_add_u32 v3, v27, 4, v26
    v_add_u32 v4, 12288, v2
    v_add_u32 v5, 18432, v3
    v_add_u32 v3, 6144, v3
    v_lshrrev_b32 v26, 2, v0
    s_lshl_b32 s67, s62, 4
    v_add_u32 v26, s67, v26
    v_and_b32 v27, 3, v0
    v_lshlrev_b32 v27, 4, v27
    v_mul_u32_u24 v10, 896, v26
    s_mul_i32 s68, s61, 56
    v_add3_u32 v10, v10, v27, s68
    v_mul_u32_u24 v11, 56, v26
    v_add_u32 v11, v11, v27
    v_add_u32 v26, s67, v24
    v_mul_u32_u24 v26, 3584, v26
    v_and_b32 v27, 15, v0
    v_lshlrev_b32 v25, 2, v24
    v_xor_b32 v27, v27, v25
    v_lshl_add_u32 v26, v27, 4, v26
    s_lshl_b32 s67, s61, 8
    v_add_u32 v6, s67, v26
    v_add_u32 v7, 13312, v6
    v_add_u32 v8, 26624, v6
    v_add_u32 v9, 39936, v6
    s_lshl_b32 s76, s62, 12
    s_lshl_b32 s77, s62, 10
    s_waitcnt lgkmcnt(0)
    s_mov_b32 s32, s4
    s_mov_b32 s33, s5
    s_mov_b32 s34, 1835008
    s_mov_b32 s35, 0x00020000
    s_mov_b32 s36, s6
    s_mov_b32 s37, s7
    s_mov_b32 s38, 401408
    s_mov_b32 s39, 0x00020000
    s_cmp_eq_u32 s63, 0
    s_cbranch_scc1 B_SPARE
    s_mov_b32 s40, s16
    s_mov_b32 s41, s17
    s_mov_b32 s42, 1605632
    s_mov_b32 s43, 0x00020000
    s_mov_b32 s44, s18
    s_mov_b32 s45, s19
    s_mov_b32 s46, 1605632
    s_mov_b32 s47, 0x00020000
    s_and_b32 s79, s60, 3
    s_mul_i32 s79, s79, 0
    s_add_u32 m0, s76, 0
    s_lshl_b32 s67, s79, 7
    buffer_load_dwordx4 v2, s[32:35], s67 offen offset:0 lds
    buffer_load_dwordx4 v3, s[32:35], s67 offen offset:1024 lds
    buffer_load_dwordx4 v4, s[32:35], s67 offen offset:2048 lds
    buffer_load_dwordx4 v5, s[32:35], s67 offen offset:3072 lds
    s_add_u32 m0, s77, 49152
    s_mul_i32 s67, s79, 57344
    buffer_load_dwordx4 v10, s[36:39], s67 offen lds
    s_and_b32 s68, s62, 1
    s_cmp_eq_u32 s68, 0
    s_cselect_b32 s52, s16, s18
    s_cselect_b32 s53, s17, s19
    s_mov_b32 s54, 1605632
    s_mov_b32 s55, 0x00020000
    s_lshl_b32 s68, s60, 2
    v_add_u32 v12, s68, v24
    v_mul_u32_u24 v12, 3584, v12
    v_and_b32 v13, 15, v0
    v_lshl_add_u32 v12, v13, 4, v12
    s_lshr_b32 s78, s62, 1
    s_mul_i32 s78, s78, 229376
    s_lshl_b32 s68, s61, 8
    s_add_u32 s78, s78, s68
    s_add_u32 m0, s76, 16384
    s_mul_i32 s67, s79, 229376
    buffer_load_dwordx4 v6, s[40:43], s67 offen offset:0 lds
    buffer_load_dwordx4 v7, s[40:43], s67 offen offset:1024 lds
    buffer_load_dwordx4 v8, s[40:43], s67 offen offset:2048 lds
    buffer_load_dwordx4 v9, s[40:43], s67 offen offset:3072 lds
    s_add_u32 m0, s76, 32768
    s_mul_i32 s67, s79, 229376
    buffer_load_dwordx4 v6, s[44:47], s67 offen offset:0 lds
    buffer_load_dwordx4 v7, s[44:47], s67 offen offset:1024 lds
    buffer_load_dwordx4 v8, s[44:47], s67 offen offset:2048 lds
    buffer_load_dwordx4 v9, s[44:47], s67 offen offset:3072 lds
    s_add_u32 s79, s79, 1
    s_cmp_eq_u32 s79, 7
    s_cselect_b32 s79, 0, s79
    s_lshl_b32 s68, s31, 2
    s_add_u32 s68, s68, s62
    s_mul_i32 s68, s68, 448
    s_mov_b64 exec, 0xfffffff
    buffer_load_dwordx4 v[32:35], v1, s[36:39], s68 offen
    s_mov_b64 exec, -1
    s_add_u32 s68, s78, 229376
    buffer_load_dwordx4 v[32:35], v12, s[52:55], s68 offen
    s_lshl_b32 s68, s60, 4
    s_add_u32 s68, s68, s61
    s_lshl_b32 s68, s68, 2
    s_add_u32 s68, s68, s62
    s_mul_i32 s68, s68, 1792
    buffer_load_dwordx4 v[32:35], v1, s[32:35], s68 offen
    buffer_load_dwordx4 v[32:35], v1, s[32:35], s68 offen offset:768
    s_add_u32 m0, s76, 53248
    s_lshl_b32 s67, s79, 7
    buffer_load_dwordx4 v2, s[32:35], s67 offen offset:0 lds
    buffer_load_dwordx4 v3, s[32:35], s67 offen offset:1024 lds
    buffer_load_dwordx4 v4, s[32:35], s67 offen offset:2048 lds
    buffer_load_dwordx4 v5, s[32:35], s67 offen offset:3072 lds
    s_add_u32 m0, s77, 102400
    s_mul_i32 s67, s79, 57344
    buffer_load_dwordx4 v10, s[36:39], s67 offen lds
    s_add_u32 m0, s76, 69632
    s_mul_i32 s67, s79, 229376
    buffer_load_dwordx4 v6, s[40:43], s67 offen offset:0 lds
    s_waitcnt vmcnt(10)
    s_barrier
    buffer_load_dwordx4 v7, s[40:43], s67 offen offset:1024 lds
    buffer_load_dwordx4 v8, s[40:43], s67 offen offset:2048 lds
    buffer_load_dwordx4 v9, s[40:43], s67 offen offset:3072 lds
    s_add_u32 m0, s76, 86016
    s_mul_i32 s67, s79, 229376
    buffer_load_dwordx4 v6, s[44:47], s67 offen offset:0 lds
    buffer_load_dwordx4 v7, s[44:47], s67 offen offset:1024 lds
    buffer_load_dwordx4 v8, s[44:47], s67 offen offset:2048 lds
    buffer_load_dwordx4 v9, s[44:47], s67 offen offset:3072 lds
    s_add_u32 s79, s79, 1
    s_cmp_eq_u32 s79, 7
    s_cselect_b32 s79, 0, s79
    s_add_u32 s68, s78, 688128
    buffer_load_dwordx4 v[32:35], v12, s[52:55], s68 offen
    s_add_u32 s68, s78, 1146880
    buffer_load_dwordx4 v[32:35], v12, s[52:55], s68 offen
    s_add_u32 m0, s76, 106496
    s_lshl_b32 s67, s79, 7
    buffer_load_dwordx4 v2, s[32:35], s67 offen offset:0 lds
    buffer_load_dwordx4 v3, s[32:35], s67 offen offset:1024 lds
    buffer_load_dwordx4 v4, s[32:35], s67 offen offset:2048 lds
    buffer_load_dwordx4 v5, s[32:35], s67 offen offset:3072 lds
    s_add_u32 m0, s77, 155648
    s_mul_i32 s67, s79, 57344
    buffer_load_dwordx4 v10, s[36:39], s67 offen lds
    s_add_u32 m0, s76, 122880
    s_mul_i32 s67, s79, 229376
    buffer_load_dwordx4 v6, s[40:43], s67 offen offset:0 lds
    buffer_load_dwordx4 v7, s[40:43], s67 offen offset:1024 lds
    buffer_load_dwordx4 v8, s[40:43], s67 offen offset:2048 lds
    s_waitcnt vmcnt(10)
    s_barrier
    buffer_load_dwordx4 v9, s[40:43], s67 offen offset:3072 lds
    s_add_u32 m0, s76, 139264
    s_mul_i32 s67, s79, 229376
    buffer_load_dwordx4 v6, s[44:47], s67 offen offset:0 lds
    buffer_load_dwordx4 v7, s[44:47], s67 offen offset:1024 lds
    buffer_load_dwordx4 v8, s[44:47], s67 offen offset:2048 lds
    buffer_load_dwordx4 v9, s[44:47], s67 offen offset:3072 lds
    s_add_u32 s79, s79, 1
    s_cmp_eq_u32 s79, 7
    s_cselect_b32 s79, 0, s79
    s_add_u32 m0, s76, 0
    s_lshl_b32 s67, s79, 7
    buffer_load_dwordx4 v2, s[32:35], s67 offen offset:0 lds
    buffer_load_dwordx4 v3, s[32:35], s67 offen offset:1024 lds
    buffer_load_dwordx4 v4, s[32:35], s67 offen offset:2048 lds
    buffer_load_dwordx4 v5, s[32:35], s67 offen offset:3072 lds
    s_add_u32 m0, s77, 49152
    s_mul_i32 s67, s79, 57344
    buffer_load_dwordx4 v10, s[36:39], s67 offen lds
    s_add_u32 m0, s76, 16384
    s_mul_i32 s67, s79, 229376
    buffer_load_dwordx4 v6, s[40:43], s67 offen offset:0 lds
    buffer_load_dwordx4 v7, s[40:43], s67 offen offset:1024 lds
    buffer_load_dwordx4 v8, s[40:43], s67 offen offset:2048 lds
    buffer_load_dwordx4 v9, s[40:43], s67 offen offset:3072 lds
    s_add_u32 m0, s76, 32768
    s_mul_i32 s67, s79, 229376
    buffer_load_dwordx4 v6, s[44:47], s67 offen offset:0 lds
    s_waitcnt vmcnt(10)
    s_barrier
    buffer_load_dwordx4 v7, s[44:47], s67 offen offset:1024 lds
    buffer_load_dwordx4 v8, s[44:47], s67 offen offset:2048 lds
    buffer_load_dwordx4 v9, s[44:47], s67 offen offset:3072 lds
    s_add_u32 s79, s79, 1
    s_cmp_eq_u32 s79, 7
    s_cselect_b32 s79, 0, s79
    s_add_u32 m0, s76, 53248
    s_lshl_b32 s67, s79, 7
    buffer_load_dwordx4 v2, s[32:35], s67 offen offset:0 lds
    buffer_load_dwordx4 v3, s[32:35], s67 offen offset:1024 lds
    buffer_load_dwordx4 v4, s[32:35], s67 offen offset:2048 lds
    buffer_load_dwordx4 v5, s[32:35], s67 offen offset:3072 lds
    s_add_u32 m0, s77, 102400
    s_mul_i32 s67, s79, 57344
    buffer_load_dwordx4 v10, s[36:39], s67 offen lds
    s_add_u32 m0, s76, 69632
    s_mul_i32 s67, s79, 229376
    buffer_load_dwordx4 v6, s[40:43], s67 offen offset:0 lds
    buffer_load_dwordx4 v7, s[40:43], s67 offen offset:1024 lds
    buffer_load_dwordx4 v8, s[40:43], s67 offen offset:2048 lds
    buffer_load_dwordx4 v9, s[40:43], s67 offen offset:3072 lds
    s_add_u32 m0, s76, 86016
    s_mul_i32 s67, s79, 229376
    buffer_load_dwordx4 v6, s[44:47], s67 offen offset:0 lds
    buffer_load_dwordx4 v7, s[44:47], s67 offen offset:1024 lds
    buffer_load_dwordx4 v8, s[44:47], s67 offen offset:2048 lds
    buffer_load_dwordx4 v9, s[44:47], s67 offen offset:3072 lds
    s_add_u32 s79, s79, 1
    s_cmp_eq_u32 s79, 7
    s_cselect_b32 s79, 0, s79
    s_waitcnt vmcnt(13)
    s_barrier
    s_add_u32 m0, s76, 106496
    s_lshl_b32 s67, s79, 7
    buffer_load_dwordx4 v2, s[32:35], s67 offen offset:0 lds
    buffer_load_dwordx4 v3, s[32:35], s67 offen offset:1024 lds
    buffer_load_dwordx4 v4, s[32:35], s67 offen offset:2048 lds
    buffer_load_dwordx4 v5, s[32:35], s67 offen offset:3072 lds
    s_add_u32 m0, s77, 155648
    s_mul_i32 s67, s79, 57344
    buffer_load_dwordx4 v10, s[36:39], s67 offen lds
    s_add_u32 m0, s76, 122880
    s_mul_i32 s67, s79, 229376
    buffer_load_dwordx4 v6, s[40:43], s67 offen offset:0 lds
    buffer_load_dwordx4 v7, s[40:43], s67 offen offset:1024 lds
    buffer_load_dwordx4 v8, s[40:43], s67 offen offset:2048 lds
    buffer_load_dwordx4 v9, s[40:43], s67 offen offset:3072 lds
    s_add_u32 m0, s76, 139264
    s_mul_i32 s67, s79, 229376
    buffer_load_dwordx4 v6, s[44:47], s67 offen offset:0 lds
    buffer_load_dwordx4 v7, s[44:47], s67 offen offset:1024 lds
    buffer_load_dwordx4 v8, s[44:47], s67 offen offset:2048 lds
    buffer_load_dwordx4 v9, s[44:47], s67 offen offset:3072 lds
    s_add_u32 s79, s79, 1
    s_cmp_eq_u32 s79, 7
    s_cselect_b32 s79, 0, s79
    s_waitcnt vmcnt(13)
    s_barrier
    s_add_u32 m0, s76, 0
    s_lshl_b32 s67, s79, 7
    buffer_load_dwordx4 v2, s[32:35], s67 offen offset:0 lds
    buffer_load_dwordx4 v3, s[32:35], s67 offen offset:1024 lds
    buffer_load_dwordx4 v4, s[32:35], s67 offen offset:2048 lds
    buffer_load_dwordx4 v5, s[32:35], s67 offen offset:3072 lds
    s_add_u32 m0, s77, 49152
    s_mul_i32 s67, s79, 57344
    buffer_load_dwordx4 v10, s[36:39], s67 offen lds
    s_add_u32 m0, s76, 16384
    s_mul_i32 s67, s79, 229376
    buffer_load_dwordx4 v6, s[40:43], s67 offen offset:0 lds
    buffer_load_dwordx4 v7, s[40:43], s67 offen offset:1024 lds
    buffer_load_dwordx4 v8, s[40:43], s67 offen offset:2048 lds
    buffer_load_dwordx4 v9, s[40:43], s67 offen offset:3072 lds
    s_add_u32 m0, s76, 32768
    s_mul_i32 s67, s79, 229376
    buffer_load_dwordx4 v6, s[44:47], s67 offen offset:0 lds
    buffer_load_dwordx4 v7, s[44:47], s67 offen offset:1024 lds
    buffer_load_dwordx4 v8, s[44:47], s67 offen offset:2048 lds
    buffer_load_dwordx4 v9, s[44:47], s67 offen offset:3072 lds
    s_add_u32 s79, s79, 1
    s_cmp_eq_u32 s79, 7
    s_cselect_b32 s79, 0, s79
    s_mov_b32 s48, s28
    s_mov_b32 s49, s29
    s_mov_b32 s50, 16777216
    s_mov_b32 s51, 0x00020000
    v_mov_b32 v15, 159744
    ds_read_b32 v16, v15
    v_lshlrev_b32 v12, 7, v0
    s_mul_i32 s74, s62, 12288
    s_add_u32 s74, s74, 53248
    v_add_u32 v2, s74, v1
    s_mov_b32 s40, s20
    s_mov_b32 s41, s21
    s_mov_b32 s42, 1605632
    s_mov_b32 s43, 0x00020000
    s_mov_b32 s44, s12
    s_mov_b32 s45, s13
    s_mov_b32 s46, 401408
    s_mov_b32 s47, 0x00020000
    v_lshrrev_b32 v13, 3, v0
    v_mul_u32_u24 v4, 896, v13
    v_bfe_u32 v13, v0, 4, 1
    v_lshlrev_b32 v13, 2, v13
    v_and_b32 v14, 7, v0
    v_xor_b32 v13, v13, v14
    v_lshl_add_u32 v4, v13, 4, v4
    s_lshl_b32 s67, s65, 7
    v_add_u32 v4, s67, v4
    v_add_u32 v5, 6144, v4
    s_mul_i32 s82, s62, 401408
    s_waitcnt vmcnt(13)
    s_barrier
    s_xor_b32 s67, s62, 0
    s_lshl_b32 s68, s60, 2
    s_add_u32 s67, s67, s68
    s_mul_i32 s67, s67, 144
    s_lshl_b32 s68, s61, 3
    s_add_u32 s67, s67, s68
    s_and_b32 s68, s62, 1
    s_lshl_b32 s68, s68, 2
    s_add_u32 s67, s67, s68
    s_lshl_b32 s67, s67, 10
    s_add_u32 s80, s67, 1048576
    s_xor_b32 s67, s62, 1
    s_lshl_b32 s68, s60, 2
    s_add_u32 s67, s67, s68
    s_mul_i32 s67, s67, 144
    s_lshl_b32 s68, s61, 3
    s_add_u32 s67, s67, s68
    s_and_b32 s68, s62, 1
    s_lshl_b32 s68, s68, 2
    s_add_u32 s67, s67, s68
    s_lshl_b32 s67, s67, 10
    s_add_u32 s81, s67, 1048576
    s_lshr_b32 s75, s62, 1
    s_lshl_b32 s76, s65, 1
    s_add_u32 s76, s76, s75
    s_and_b32 s59, s62, 1
    s_lshl_b32 s78, s30, 1
    s_add_u32 s78, s78, s59
    s_xor_b32 s67, s78, 0
    s_mul_i32 s67, s67, 147456
    s_add_u32 s67, s67, 1048576
    v_add_u32 v6, s67, v1
    s_xor_b32 s67, s78, 1
    s_mul_i32 s67, s67, 147456
    s_add_u32 s67, s67, 1048576
    v_add_u32 v7, s67, v1
    v_lshrrev_b32 v13, 5, v0
    v_bfe_u32 v14, v0, 2, 2
    v_bfe_u32 v11, v0, 4, 1
    v_lshlrev_b32 v11, 5, v11
    v_and_b32 v9, 3, v0
    v_lshl_add_u32 v11, v9, 3, v11
    v_lshl_add_u32 v9, v13, 3, v14
    v_lshl_add_u32 v9, v13, 2, v14
    v_lshl_add_u32 v9, v9, 7, v11
    v_add_u32 v9, s74, v9
    v_lshrrev_b32 v14, 1, v14
    v_xor_b32 v14, s75, v14
    v_xor_b32 v13, 1, v14
    v_lshl_add_u32 v10, v13, 6, v9
    v_lshl_add_u32 v9, v14, 6, v9
    s_mul_i32 s83, s75, 7
    s_add_u32 s79, s83, 3
    s_add_u32 s67, s75, 14
    s_cmp_eq_u32 s59, 1
    s_cselect_b32 s79, s67, s79
    s_mul_i32 s79, s79, 25088
    s_lshl_b32 s67, s59, 2
    s_add_u32 s83, s83, s67
    s_mul_i32 s83, s83, 25088
    s_lshl_b32 s69, s60, 4
    s_add_u32 s69, s69, s61
    s_lshl_b32 s69, s69, 2
    s_add_u32 s69, s69, s62
    s_lshl_b32 s69, s69, 7
    s_add_u32 s54, s69, 655360
    s_add_u32 s69, s69, 524288
    s_lshr_b32 s67, s30, 1
    s_lshl_b32 s67, s67, 13
    s_add_u32 s52, s67, 524288
    s_add_u32 s53, s67, 655360
    s_lshl_b32 s67, s62, 2
    v_add_u32 v11, s67, v15
    v_lshrrev_b32 v13, 2, v0
    v_and_b32 v14, 1, v0
    v_lshl_add_u32 v13, v13, 1, v14
    s_mul_i32 s67, s62, 7
    v_subrev_u32 v13, s67, v13
    v_cmp_gt_u32 s[56:57], 7, v13
    v_bfe_u32 v14, v0, 1, 1
    s_and_b32 s67, s30, 1
    v_cmp_eq_u32 vcc, s67, v14
    s_and_b64 s[56:57], s[56:57], vcc
    s_mul_i32 s73, s62, 28672
    v_mov_b32 v17, 0
    s_waitcnt lgkmcnt(0)
    v_readfirstlane_b32 s66, v16
    s_waitcnt vmcnt(0)
    s_barrier
    s_lshl_b32 s67, s60, 2
    s_add_u32 s67, s67, s62
    s_mul_i32 s67, s67, 72
    s_cmp_ge_u32 s61, 7
    s_addc_u32 s68, s61, 0
    s_cmp_eq_u32 s61, 14
    s_cselect_b32 s68, 7, s68
    s_min_u32 s68, s68, 15
    s_add_u32 s67, s67, s68
    s_add_u32 s67, s67, 56
    s_lshl_b32 s67, s67, 11
    s_add_u32 s67, s67, 1048576
    v_mov_b32 v20, -1
    v_mov_b32 v21, -1
    v_mov_b32 v22, -1
    v_mov_b32 v23, -1
    buffer_store_dwordx4 v[20:23], v1, s[48:51], s67 offen sc1
    buffer_store_dwordx4 v[20:23], v1, s[48:51], s67 offen offset:1024 sc1
    s_mov_b32 s72, 1048576
LS1:
    ds_read_b32 v13, v11 offset:48
    s_waitcnt lgkmcnt(0)
    v_readfirstlane_b32 s70, v13
    s_cmp_ge_u32 s70, 1
    s_cbranch_scc1 LS1D
    s_sleep 1
    s_sub_u32 s72, s72, 1
    s_cmp_lg_u32 s72, 0
    s_cbranch_scc1 LS1
LS1D:
    s_add_u32 s67, s82, 0
    buffer_load_dwordx4 v[80:83], v4, s[40:43], s67 offen
    buffer_load_dwordx4 v[84:87], v5, s[40:43], s67 offen offset:1024
    s_add_u32 s67, s82, 14336
    buffer_load_dwordx4 v[88:91], v4, s[40:43], s67 offen
    buffer_load_dwordx4 v[92:95], v5, s[40:43], s67 offen offset:1024
    s_add_u32 s67, s82, 57344
    buffer_load_dwordx4 v[96:99], v4, s[40:43], s67 offen
    buffer_load_dwordx4 v[100:103], v5, s[40:43], s67 offen offset:1024
    s_add_u32 s67, s82, 71680
    buffer_load_dwordx4 v[104:107], v4, s[40:43], s67 offen
    buffer_load_dwordx4 v[108:111], v5, s[40:43], s67 offen offset:1024
    s_add_u32 s67, s82, 114688
    buffer_load_dwordx4 v[112:115], v4, s[40:43], s67 offen
    buffer_load_dwordx4 v[116:119], v5, s[40:43], s67 offen offset:1024
    s_add_u32 s67, s82, 129024
    buffer_load_dwordx4 v[120:123], v4, s[40:43], s67 offen
    buffer_load_dwordx4 v[124:127], v5, s[40:43], s67 offen offset:1024
    s_add_u32 s67, s82, 172032
    buffer_load_dwordx4 v[128:131], v4, s[40:43], s67 offen
    buffer_load_dwordx4 v[132:135], v5, s[40:43], s67 offen offset:1024
    s_add_u32 s67, s82, 186368
    buffer_load_dwordx4 v[136:139], v4, s[40:43], s67 offen
    buffer_load_dwordx4 v[140:143], v5, s[40:43], s67 offen offset:1024
    s_mov_b32 s72, 1048576
LS2:
    ds_read_b32 v13, v11 offset:16
    s_waitcnt lgkmcnt(0)
    v_readfirstlane_b32 s70, v13
    s_cmp_ge_u32 s70, 1
    s_cbranch_scc1 LS2D
    s_sleep 1
    s_sub_u32 s72, s72, 1
    s_cmp_lg_u32 s72, 0
    s_cbranch_scc1 LS2
LS2D:
    s_setprio 3
    ds_read_b128 v[32:35], v2 offset:0
    ds_read_b128 v[36:39], v2 offset:1024
    ds_read_b128 v[40:43], v2 offset:2048
    ds_read_b128 v[44:47], v2 offset:3072
    s_waitcnt lgkmcnt(3)
    buffer_store_dwordx4 v[32:35], v1, s[48:51], s80 offen offset:0 sc1
    s_waitcnt lgkmcnt(2)
    buffer_store_dwordx4 v[36:39], v1, s[48:51], s80 offen offset:1024 sc1
    s_waitcnt lgkmcnt(1)
    buffer_store_dwordx4 v[40:43], v1, s[48:51], s81 offen offset:0 sc1
    s_waitcnt lgkmcnt(0)
    buffer_store_dwordx4 v[44:47], v1, s[48:51], s81 offen offset:1024 sc1
    s_setprio 0
    s_waitcnt vmcnt(18) lgkmcnt(6)
    ds_write_b128 v2, v[80:83] offset:8192
    ds_write_b128 v2, v[84:87] offset:9216
    ds_read_b64_tr_b16 v[80:81], v9 offset:8192
    ds_read_b64_tr_b16 v[82:83], v9 offset:9216
    ds_read_b64_tr_b16 v[84:85], v10 offset:8192
    ds_read_b64_tr_b16 v[86:87], v10 offset:9216
    s_waitcnt vmcnt(16) lgkmcnt(6)
    ds_write_b128 v2, v[88:91] offset:8192
    ds_write_b128 v2, v[92:95] offset:9216
    ds_read_b64_tr_b16 v[88:89], v9 offset:8192
    ds_read_b64_tr_b16 v[90:91], v9 offset:9216
    ds_read_b64_tr_b16 v[92:93], v10 offset:8192
    ds_read_b64_tr_b16 v[94:95], v10 offset:9216
    s_waitcnt vmcnt(14) lgkmcnt(6)
    ds_write_b128 v2, v[96:99] offset:8192
    ds_write_b128 v2, v[100:103] offset:9216
    ds_read_b64_tr_b16 v[96:97], v9 offset:8192
    ds_read_b64_tr_b16 v[98:99], v9 offset:9216
    ds_read_b64_tr_b16 v[100:101], v10 offset:8192
    ds_read_b64_tr_b16 v[102:103], v10 offset:9216
    s_waitcnt vmcnt(12) lgkmcnt(6)
    ds_write_b128 v2, v[104:107] offset:8192
    ds_write_b128 v2, v[108:111] offset:9216
    ds_read_b64_tr_b16 v[104:105], v9 offset:8192
    ds_read_b64_tr_b16 v[106:107], v9 offset:9216
    ds_read_b64_tr_b16 v[108:109], v10 offset:8192
    ds_read_b64_tr_b16 v[110:111], v10 offset:9216
    s_waitcnt vmcnt(0)
    s_mov_b64 exec, 1
    buffer_store_dword v16, v17, s[48:51], s69 offen sc1
    s_mov_b64 exec, -1
    s_mov_b32 s72, 1048576
LS3:
    ds_read_b32 v13, v11 offset:16
    s_waitcnt lgkmcnt(0)
    v_readfirstlane_b32 s70, v13
    s_cmp_ge_u32 s70, 2
    s_cbranch_scc1 LS3D
    s_sleep 1
    s_sub_u32 s72, s72, 1
    s_cmp_lg_u32 s72, 0
    s_cbranch_scc1 LS3
LS3D:
    s_setprio 3
    ds_read_b128 v[48:51], v2 offset:4096
    ds_read_b128 v[52:55], v2 offset:5120
    ds_read_b128 v[56:59], v2 offset:6144
    ds_read_b128 v[60:63], v2 offset:7168
    s_waitcnt lgkmcnt(3)
    buffer_store_dwordx4 v[48:51], v1, s[48:51], s80 offen offset:2048 sc1
    s_waitcnt lgkmcnt(2)
    buffer_store_dwordx4 v[52:55], v1, s[48:51], s80 offen offset:3072 sc1
    s_waitcnt lgkmcnt(1)
    buffer_store_dwordx4 v[56:59], v1, s[48:51], s81 offen offset:2048 sc1
    s_waitcnt lgkmcnt(0)
    buffer_store_dwordx4 v[60:63], v1, s[48:51], s81 offen offset:3072 sc1
    s_setprio 0
    s_waitcnt lgkmcnt(6)
    ds_write_b128 v2, v[112:115] offset:8192
    ds_write_b128 v2, v[116:119] offset:9216
    ds_read_b64_tr_b16 v[112:113], v9 offset:8192
    ds_read_b64_tr_b16 v[114:115], v9 offset:9216
    ds_read_b64_tr_b16 v[116:117], v10 offset:8192
    ds_read_b64_tr_b16 v[118:119], v10 offset:9216
    s_waitcnt lgkmcnt(6)
    ds_write_b128 v2, v[120:123] offset:8192
    ds_write_b128 v2, v[124:127] offset:9216
    ds_read_b64_tr_b16 v[120:121], v9 offset:8192
    ds_read_b64_tr_b16 v[122:123], v9 offset:9216
    ds_read_b64_tr_b16 v[124:125], v10 offset:8192
    ds_read_b64_tr_b16 v[126:127], v10 offset:9216
    s_waitcnt lgkmcnt(6)
    ds_write_b128 v2, v[128:131] offset:8192
    ds_write_b128 v2, v[132:135] offset:9216
    ds_read_b64_tr_b16 v[128:129], v9 offset:8192
    ds_read_b64_tr_b16 v[130:131], v9 offset:9216
    ds_read_b64_tr_b16 v[132:133], v10 offset:8192
    ds_read_b64_tr_b16 v[134:135], v10 offset:9216
    s_waitcnt lgkmcnt(6)
    ds_write_b128 v2, v[136:139] offset:8192
    ds_write_b128 v2, v[140:143] offset:9216
    ds_read_b64_tr_b16 v[136:137], v9 offset:8192
    ds_read_b64_tr_b16 v[138:139], v9 offset:9216
    ds_read_b64_tr_b16 v[140:141], v10 offset:8192
    ds_read_b64_tr_b16 v[142:143], v10 offset:9216
    s_waitcnt vmcnt(0)
    s_mov_b64 exec, 1
    buffer_store_dword v16, v17, s[48:51], s54 offen sc1
    s_mov_b64 exec, -1
    s_mov_b32 s72, 65536
    s_mov_b64 exec, s[56:57]
POLL4:
    buffer_load_dword v13, v12, s[48:51], s52 offen sc1
    s_waitcnt vmcnt(0)
    v_cmp_eq_u32 vcc, s66, v13
    s_cmp_eq_u64 vcc, exec
    s_cbranch_scc1 POLL4D
    s_sleep 2
    s_sub_u32 s72, s72, 1
    s_cmp_lg_u32 s72, 0
    s_cbranch_scc1 POLL4
POLL4D:
    s_mov_b64 exec, -1
    s_add_u32 s67, s73, 0
    buffer_load_dwordx4 v[144:147], v6, s[48:51], s67 offen offset:0 sc1
    buffer_load_dwordx4 v[148:151], v7, s[48:51], s67 offen offset:0 sc1
    s_add_u32 s67, s73, 0
    buffer_load_dwordx4 v[152:155], v6, s[48:51], s67 offen offset:1024 sc1
    buffer_load_dwordx4 v[156:159], v7, s[48:51], s67 offen offset:1024 sc1
    s_add_u32 s67, s73, 4096
    buffer_load_dwordx4 v[160:163], v6, s[48:51], s67 offen offset:0 sc1
    buffer_load_dwordx4 v[164:167], v7, s[48:51], s67 offen offset:0 sc1
    s_add_u32 s67, s73, 4096
    buffer_load_dwordx4 v[168:171], v6, s[48:51], s67 offen offset:1024 sc1
    buffer_load_dwordx4 v[172:175], v7, s[48:51], s67 offen offset:1024 sc1
    s_add_u32 s67, s73, 8192
    buffer_load_dwordx4 v[176:179], v6, s[48:51], s67 offen offset:0 sc1
    buffer_load_dwordx4 v[180:183], v7, s[48:51], s67 offen offset:0 sc1
    s_add_u32 s67, s73, 8192
    buffer_load_dwordx4 v[184:187], v6, s[48:51], s67 offen offset:1024 sc1
    buffer_load_dwordx4 v[188:191], v7, s[48:51], s67 offen offset:1024 sc1
    s_add_u32 s67, s73, 12288
    buffer_load_dwordx4 v[192:195], v6, s[48:51], s67 offen offset:0 sc1
    buffer_load_dwordx4 v[196:199], v7, s[48:51], s67 offen offset:0 sc1
    s_add_u32 s67, s73, 12288
    buffer_load_dwordx4 v[200:203], v6, s[48:51], s67 offen offset:1024 sc1
    buffer_load_dwordx4 v[204:207], v7, s[48:51], s67 offen offset:1024 sc1
    s_mov_b32 s72, 1048576
LS5:
    ds_read_b32 v13, v15 offset:8
    s_waitcnt lgkmcnt(0)
    v_readfirstlane_b32 s70, v13
    s_cmp_ge_u32 s70, 4
    s_cbranch_scc1 LS5D
    s_sub_u32 s72, s72, 1
    s_cmp_lg_u32 s72, 0
    s_cbranch_scc1 LS5
LS5D:
    s_add_u32 m0, s74, 63488
    s_add_u32 s67, s82, 229376
    buffer_load_dwordx4 v4, s[40:43], s67 offen lds
    buffer_load_dwordx4 v5, s[40:43], s67 offen offset:1024 lds
    s_add_u32 m0, s74, 0
    s_add_u32 s67, s82, 243712
    buffer_load_dwordx4 v4, s[40:43], s67 offen lds
    buffer_load_dwordx4 v5, s[40:43], s67 offen offset:1024 lds
    s_add_u32 m0, s74, 2048
    s_add_u32 s67, s82, 286720
    buffer_load_dwordx4 v4, s[40:43], s67 offen lds
    buffer_load_dwordx4 v5, s[40:43], s67 offen offset:1024 lds
    v_and_b32 v3, 31, v0
    v_lshlrev_b32 v3, 2, v3
    s_lshl_b32 s67, s78, 7
    s_add_u32 s67, s67, 262144
    buffer_load_dword v8, v3, s[48:51], s67 offen sc1
    s_waitcnt vmcnt(21) lgkmcnt(0)
    v_mfma_f32_32x32x16_bf16 v[48:63], v[80:83], v[148:151], 0
    v_mfma_f32_32x32x16_bf16 v[64:79], v[84:87], v[148:151], 0
    v_mfma_f32_32x32x16_bf16 v[16:31], v[80:83], v[144:147], 0
    v_mfma_f32_32x32x16_bf16 v[32:47], v[84:87], v[144:147], 0
    s_add_u32 s67, s73, 16384
    buffer_load_dwordx4 v[208:211], v6, s[48:51], s67 offen offset:0 sc1
    buffer_load_dwordx4 v[212:215], v7, s[48:51], s67 offen offset:0 sc1
    s_add_u32 m0, s74, 4096
    s_add_u32 s67, s82, 301056
    buffer_load_dwordx4 v4, s[40:43], s67 offen lds
    buffer_load_dwordx4 v5, s[40:43], s67 offen offset:1024 lds
    s_waitcnt vmcnt(23) lgkmcnt(0)
    v_mfma_f32_32x32x16_bf16 v[48:63], v[88:91], v[156:159], v[48:63]
    v_mfma_f32_32x32x16_bf16 v[64:79], v[92:95], v[156:159], v[64:79]
    v_mfma_f32_32x32x16_bf16 v[16:31], v[88:91], v[152:155], v[16:31]
    v_mfma_f32_32x32x16_bf16 v[32:47], v[92:95], v[152:155], v[32:47]
    s_add_u32 s67, s73, 16384
    buffer_load_dwordx4 v[216:219], v6, s[48:51], s67 offen offset:1024 sc1
    buffer_load_dwordx4 v[220:223], v7, s[48:51], s67 offen offset:1024 sc1
    s_add_u32 m0, s74, 6144
    s_add_u32 s67, s82, 344064
    buffer_load_dwordx4 v4, s[40:43], s67 offen lds
    buffer_load_dwordx4 v5, s[40:43], s67 offen offset:1024 lds
    s_waitcnt vmcnt(25) lgkmcnt(0)
    v_mfma_f32_32x32x16_bf16 v[48:63], v[96:99], v[164:167], v[48:63]
    v_mfma_f32_32x32x16_bf16 v[64:79], v[100:103], v[164:167], v[64:79]
    v_mfma_f32_32x32x16_bf16 v[16:31], v[96:99], v[160:163], v[16:31]
    v_mfma_f32_32x32x16_bf16 v[32:47], v[100:103], v[160:163], v[32:47]
    s_mov_b64 exec, s[56:57]
    buffer_load_dword v13, v12, s[48:51], s53 offen sc1
    s_mov_b64 exec, -1
    s_add_u32 s67, s73, 20480
    buffer_load_dwordx4 v[224:227], v6, s[48:51], s67 offen offset:0 sc1
    buffer_load_dwordx4 v[228:231], v7, s[48:51], s67 offen offset:0 sc1
    s_add_u32 m0, s74, 8192
    s_add_u32 s67, s82, 358400
    buffer_load_dwordx4 v4, s[40:43], s67 offen lds
    buffer_load_dwordx4 v5, s[40:43], s67 offen offset:1024 lds
    s_waitcnt vmcnt(28) lgkmcnt(0)
    v_mfma_f32_32x32x16_bf16 v[48:63], v[104:107], v[172:175], v[48:63]
    v_mfma_f32_32x32x16_bf16 v[64:79], v[108:111], v[172:175], v[64:79]
    v_mfma_f32_32x32x16_bf16 v[16:31], v[104:107], v[168:171], v[16:31]
    v_mfma_f32_32x32x16_bf16 v[32:47], v[108:111], v[168:171], v[32:47]
    s_add_u32 s67, s73, 20480
    buffer_load_dwordx4 v[232:235], v6, s[48:51], s67 offen offset:1024 sc1
    buffer_load_dwordx4 v[236:239], v7, s[48:51], s67 offen offset:1024 sc1
    s_add_u32 m0, s74, 53248
    s_add_u32 s67, s82, 28672
    buffer_load_dwordx4 v4, s[40:43], s67 offen lds
    buffer_load_dwordx4 v5, s[40:43], s67 offen offset:1024 lds
    s_waitcnt vmcnt(30) lgkmcnt(0)
    v_mfma_f32_32x32x16_bf16 v[48:63], v[112:115], v[180:183], v[48:63]
    v_mfma_f32_32x32x16_bf16 v[64:79], v[116:119], v[180:183], v[64:79]
    v_mfma_f32_32x32x16_bf16 v[16:31], v[112:115], v[176:179], v[16:31]
    v_mfma_f32_32x32x16_bf16 v[32:47], v[116:119], v[176:179], v[32:47]
    s_add_u32 s67, s73, 24576
    buffer_load_dwordx4 v[240:243], v6, s[48:51], s67 offen offset:0 sc1
    buffer_load_dwordx4 v[244:247], v7, s[48:51], s67 offen offset:0 sc1
    s_add_u32 m0, s74, 55296
    s_add_u32 s67, s82, 43008
    buffer_load_dwordx4 v4, s[40:43], s67 offen lds
    buffer_load_dwordx4 v5, s[40:43], s67 offen offset:1024 lds
    s_waitcnt vmcnt(32) lgkmcnt(0)
    v_mfma_f32_32x32x16_bf16 v[48:63], v[120:123], v[188:191], v[48:63]
    v_mfma_f32_32x32x16_bf16 v[64:79], v[124:127], v[188:191], v[64:79]
    v_mfma_f32_32x32x16_bf16 v[16:31], v[120:123], v[184:187], v[16:31]
    v_mfma_f32_32x32x16_bf16 v[32:47], v[124:127], v[184:187], v[32:47]
    s_add_u32 s67, s73, 24576
    buffer_load_dwordx4 v[248:251], v6, s[48:51], s67 offen offset:1024 sc1
    buffer_load_dwordx4 v[252:255], v7, s[48:51], s67 offen offset:1024 sc1
    s_add_u32 m0, s74, 57344
    s_add_u32 s67, s82, 86016
    buffer_load_dwordx4 v4, s[40:43], s67 offen lds
    buffer_load_dwordx4 v5, s[40:43], s67 offen offset:1024 lds
    s_waitcnt vmcnt(30)
    ds_read_b64_tr_b16 v[80:81], v9 offset:63488
    ds_read_b64_tr_b16 v[82:83], v9 offset:64512
    ds_read_b64_tr_b16 v[84:85], v10 offset:63488
    ds_read_b64_tr_b16 v[86:87], v10 offset:64512
    s_waitcnt lgkmcnt(4)
    v_mfma_f32_32x32x16_bf16 v[48:63], v[128:131], v[196:199], v[48:63]
    v_mfma_f32_32x32x16_bf16 v[64:79], v[132:135], v[196:199], v[64:79]
    v_mfma_f32_32x32x16_bf16 v[16:31], v[128:131], v[192:195], v[16:31]
    v_mfma_f32_32x32x16_bf16 v[32:47], v[132:135], v[192:195], v[32:47]
    s_waitcnt vmcnt(16)
    v_cmp_eq_u32 vcc, s66, v13
    s_and_b64 vcc, vcc, s[56:57]
    s_cmp_eq_u64 vcc, s[56:57]
    s_cbranch_scc0 SL6
SL6B:
    s_add_u32 s67, s73, 0
    buffer_load_dwordx4 v[144:147], v6, s[48:51], s67 offen offset:2048 sc1
    buffer_load_dwordx4 v[148:151], v7, s[48:51], s67 offen offset:2048 sc1
    s_add_u32 m0, s74, 59392
    s_add_u32 s67, s82, 100352
    buffer_load_dwordx4 v4, s[40:43], s67 offen lds
    buffer_load_dwordx4 v5, s[40:43], s67 offen offset:1024 lds
    ds_read_b64_tr_b16 v[88:89], v9 offset:0
    ds_read_b64_tr_b16 v[90:91], v9 offset:1024
    ds_read_b64_tr_b16 v[92:93], v10 offset:0
    ds_read_b64_tr_b16 v[94:95], v10 offset:1024
    s_waitcnt lgkmcnt(4)
    v_mfma_f32_32x32x16_bf16 v[48:63], v[136:139], v[204:207], v[48:63]
    v_mfma_f32_32x32x16_bf16 v[64:79], v[140:143], v[204:207], v[64:79]
    v_mfma_f32_32x32x16_bf16 v[16:31], v[136:139], v[200:203], v[16:31]
    v_mfma_f32_32x32x16_bf16 v[32:47], v[140:143], v[200:203], v[32:47]
    s_add_u32 s67, s73, 0
    buffer_load_dwordx4 v[152:155], v6, s[48:51], s67 offen offset:3072 sc1
    buffer_load_dwordx4 v[156:159], v7, s[48:51], s67 offen offset:3072 sc1
    s_add_u32 m0, s74, 61440
    s_add_u32 s67, s82, 143360
    buffer_load_dwordx4 v4, s[40:43], s67 offen lds
    buffer_load_dwordx4 v5, s[40:43], s67 offen offset:1024 lds
    ds_read_b64_tr_b16 v[96:97], v9 offset:2048
    ds_read_b64_tr_b16 v[98:99], v9 offset:3072
    ds_read_b64_tr_b16 v[100:101], v10 offset:2048
    ds_read_b64_tr_b16 v[102:103], v10 offset:3072
    s_waitcnt lgkmcnt(4)
    v_mfma_f32_32x32x16_bf16 v[48:63], v[80:83], v[212:215], v[48:63]
    v_mfma_f32_32x32x16_bf16 v[64:79], v[84:87], v[212:215], v[64:79]
    v_mfma_f32_32x32x16_bf16 v[16:31], v[80:83], v[208:211], v[16:31]
    v_mfma_f32_32x32x16_bf16 v[32:47], v[84:87], v[208:211], v[32:47]
    s_add_u32 s67, s73, 4096
    buffer_load_dwordx4 v[160:163], v6, s[48:51], s67 offen offset:2048 sc1
    buffer_load_dwordx4 v[164:167], v7, s[48:51], s67 offen offset:2048 sc1
    s_add_u32 m0, s74, 63488
    s_add_u32 s67, s82, 157696
    buffer_load_dwordx4 v4, s[40:43], s67 offen lds
    buffer_load_dwordx4 v5, s[40:43], s67 offen offset:1024 lds
    ds_read_b64_tr_b16 v[104:105], v9 offset:4096
    ds_read_b64_tr_b16 v[106:107], v9 offset:5120
    ds_read_b64_tr_b16 v[108:109], v10 offset:4096
    ds_read_b64_tr_b16 v[110:111], v10 offset:5120
    s_waitcnt lgkmcnt(4)
    v_mfma_f32_32x32x16_bf16 v[48:63], v[88:91], v[220:223], v[48:63]
    v_mfma_f32_32x32x16_bf16 v[64:79], v[92:95], v[220:223], v[64:79]
    v_mfma_f32_32x32x16_bf16 v[16:31], v[88:91], v[216:219], v[16:31]
    v_mfma_f32_32x32x16_bf16 v[32:47], v[92:95], v[216:219], v[32:47]
    s_add_u32 s67, s73, 4096
    buffer_load_dwordx4 v[168:171], v6, s[48:51], s67 offen offset:3072 sc1
    buffer_load_dwordx4 v[172:175], v7, s[48:51], s67 offen offset:3072 sc1
    s_add_u32 m0, s74, 0
    s_add_u32 s67, s82, 200704
    buffer_load_dwordx4 v4, s[40:43], s67 offen lds
    buffer_load_dwordx4 v5, s[40:43], s67 offen offset:1024 lds
    ds_read_b64_tr_b16 v[112:113], v9 offset:6144
    ds_read_b64_tr_b16 v[114:115], v9 offset:7168
    ds_read_b64_tr_b16 v[116:117], v10 offset:6144
    ds_read_b64_tr_b16 v[118:119], v10 offset:7168
    s_waitcnt vmcnt(30) lgkmcnt(4)
    v_mfma_f32_32x32x16_bf16 v[48:63], v[96:99], v[228:231], v[48:63]
    v_mfma_f32_32x32x16_bf16 v[64:79], v[100:103], v[228:231], v[64:79]
    v_mfma_f32_32x32x16_bf16 v[16:31], v[96:99], v[224:227], v[16:31]
    v_mfma_f32_32x32x16_bf16 v[32:47], v[100:103], v[224:227], v[32:47]
    s_add_u32 s67, s73, 8192
    buffer_load_dwordx4 v[176:179], v6, s[48:51], s67 offen offset:2048 sc1
    buffer_load_dwordx4 v[180:183], v7, s[48:51], s67 offen offset:2048 sc1
    s_add_u32 m0, s74, 2048
    s_add_u32 s67, s82, 215040
    buffer_load_dwordx4 v4, s[40:43], s67 offen lds
    buffer_load_dwordx4 v5, s[40:43], s67 offen offset:1024 lds
    s_waitcnt vmcnt(32)
    ds_read_b64_tr_b16 v[120:121], v9 offset:8192
    ds_read_b64_tr_b16 v[122:123], v9 offset:9216
    ds_read_b64_tr_b16 v[124:125], v10 offset:8192
    ds_read_b64_tr_b16 v[126:127], v10 offset:9216
    s_waitcnt vmcnt(30) lgkmcnt(4)
    v_mfma_f32_32x32x16_bf16 v[48:63], v[104:107], v[236:239], v[48:63]
    v_mfma_f32_32x32x16_bf16 v[64:79], v[108:111], v[236:239], v[64:79]
    v_mfma_f32_32x32x16_bf16 v[16:31], v[104:107], v[232:235], v[16:31]
    v_mfma_f32_32x32x16_bf16 v[32:47], v[108:111], v[232:235], v[32:47]
    s_add_u32 s67, s73, 8192
    buffer_load_dwordx4 v[184:187], v6, s[48:51], s67 offen offset:3072 sc1
    buffer_load_dwordx4 v[188:191], v7, s[48:51], s67 offen offset:3072 sc1
    s_add_u32 m0, s74, 4096
    s_add_u32 s67, s82, 258048
    buffer_load_dwordx4 v4, s[40:43], s67 offen lds
    buffer_load_dwordx4 v5, s[40:43], s67 offen offset:1024 lds
    s_waitcnt vmcnt(32)
    ds_read_b64_tr_b16 v[128:129], v9 offset:53248
    ds_read_b64_tr_b16 v[130:131], v9 offset:54272
    ds_read_b64_tr_b16 v[132:133], v10 offset:53248
    ds_read_b64_tr_b16 v[134:135], v10 offset:54272
    s_waitcnt vmcnt(30) lgkmcnt(4)
    v_mfma_f32_32x32x16_bf16 v[48:63], v[112:115], v[244:247], v[48:63]
    v_mfma_f32_32x32x16_bf16 v[64:79], v[116:119], v[244:247], v[64:79]
    v_mfma_f32_32x32x16_bf16 v[16:31], v[112:115], v[240:243], v[16:31]
    v_mfma_f32_32x32x16_bf16 v[32:47], v[116:119], v[240:243], v[32:47]
    s_add_u32 s67, s73, 12288
    buffer_load_dwordx4 v[192:195], v6, s[48:51], s67 offen offset:2048 sc1
    buffer_load_dwordx4 v[196:199], v7, s[48:51], s67 offen offset:2048 sc1
    s_add_u32 m0, s74, 6144
    s_add_u32 s67, s82, 272384
    buffer_load_dwordx4 v4, s[40:43], s67 offen lds
    buffer_load_dwordx4 v5, s[40:43], s67 offen offset:1024 lds
    s_waitcnt vmcnt(32)
    ds_read_b64_tr_b16 v[136:137], v9 offset:55296
    ds_read_b64_tr_b16 v[138:139], v9 offset:56320
    ds_read_b64_tr_b16 v[140:141], v10 offset:55296
    ds_read_b64_tr_b16 v[142:143], v10 offset:56320
    s_waitcnt vmcnt(30) lgkmcnt(4)
    v_mfma_f32_32x32x16_bf16 v[48:63], v[120:123], v[252:255], v[48:63]
    v_mfma_f32_32x32x16_bf16 v[64:79], v[124:127], v[252:255], v[64:79]
    v_mfma_f32_32x32x16_bf16 v[16:31], v[120:123], v[248:251], v[16:31]
    v_mfma_f32_32x32x16_bf16 v[32:47], v[124:127], v[248:251], v[32:47]
    s_add_u32 s67, s73, 12288
    buffer_load_dwordx4 v[200:203], v6, s[48:51], s67 offen offset:3072 sc1
    buffer_load_dwordx4 v[204:207], v7, s[48:51], s67 offen offset:3072 sc1
    s_add_u32 m0, s74, 8192
    s_add_u32 s67, s82, 315392
    buffer_load_dwordx4 v4, s[40:43], s67 offen lds
    buffer_load_dwordx4 v5, s[40:43], s67 offen offset:1024 lds
    s_waitcnt vmcnt(32)
    ds_read_b64_tr_b16 v[80:81], v9 offset:57344
    ds_read_b64_tr_b16 v[82:83], v9 offset:58368
    ds_read_b64_tr_b16 v[84:85], v10 offset:57344
    ds_read_b64_tr_b16 v[86:87], v10 offset:58368
    s_waitcnt vmcnt(30) lgkmcnt(4)
    v_mfma_f32_32x32x16_bf16 v[48:63], v[128:131], v[148:151], v[48:63]
    v_mfma_f32_32x32x16_bf16 v[64:79], v[132:135], v[148:151], v[64:79]
    v_mfma_f32_32x32x16_bf16 v[16:31], v[128:131], v[144:147], v[16:31]
    v_mfma_f32_32x32x16_bf16 v[32:47], v[132:135], v[144:147], v[32:47]
    s_add_u32 s67, s73, 16384
    buffer_load_dwordx4 v[208:211], v6, s[48:51], s67 offen offset:2048 sc1
    buffer_load_dwordx4 v[212:215], v7, s[48:51], s67 offen offset:2048 sc1
    s_add_u32 m0, s74, 53248
    s_add_u32 s67, s82, 329728
    buffer_load_dwordx4 v4, s[40:43], s67 offen lds
    buffer_load_dwordx4 v5, s[40:43], s67 offen offset:1024 lds
    s_waitcnt vmcnt(32)
    ds_read_b64_tr_b16 v[88:89], v9 offset:59392
    ds_read_b64_tr_b16 v[90:91], v9 offset:60416
    ds_read_b64_tr_b16 v[92:93], v10 offset:59392
    ds_read_b64_tr_b16 v[94:95], v10 offset:60416
    s_waitcnt vmcnt(30) lgkmcnt(4)
    v_mfma_f32_32x32x16_bf16 v[48:63], v[136:139], v[156:159], v[48:63]
    v_mfma_f32_32x32x16_bf16 v[64:79], v[140:143], v[156:159], v[64:79]
    v_mfma_f32_32x32x16_bf16 v[16:31], v[136:139], v[152:155], v[16:31]
    v_mfma_f32_32x32x16_bf16 v[32:47], v[140:143], v[152:155], v[32:47]
    s_add_u32 s67, s73, 16384
    buffer_load_dwordx4 v[216:219], v6, s[48:51], s67 offen offset:3072 sc1
    buffer_load_dwordx4 v[220:223], v7, s[48:51], s67 offen offset:3072 sc1
    s_add_u32 m0, s74, 55296
    s_add_u32 s67, s82, 372736
    buffer_load_dwordx4 v4, s[40:43], s67 offen lds
    buffer_load_dwordx4 v5, s[40:43], s67 offen offset:1024 lds
    s_waitcnt vmcnt(32)
    ds_read_b64_tr_b16 v[96:97], v9 offset:61440
    ds_read_b64_tr_b16 v[98:99], v9 offset:62464
    ds_read_b64_tr_b16 v[100:101], v10 offset:61440
    ds_read_b64_tr_b16 v[102:103], v10 offset:62464
    s_waitcnt vmcnt(30) lgkmcnt(4)
    v_mfma_f32_32x32x16_bf16 v[48:63], v[80:83], v[164:167], v[48:63]
    v_mfma_f32_32x32x16_bf16 v[64:79], v[84:87], v[164:167], v[64:79]
    v_mfma_f32_32x32x16_bf16 v[16:31], v[80:83], v[160:163], v[16:31]
    v_mfma_f32_32x32x16_bf16 v[32:47], v[84:87], v[160:163], v[32:47]
    s_add_u32 s67, s73, 20480
    buffer_load_dwordx4 v[224:227], v6, s[48:51], s67 offen offset:2048 sc1
    buffer_load_dwordx4 v[228:231], v7, s[48:51], s67 offen offset:2048 sc1
    s_add_u32 m0, s74, 57344
    s_add_u32 s67, s82, 387072
    buffer_load_dwordx4 v4, s[40:43], s67 offen lds
    buffer_load_dwordx4 v5, s[40:43], s67 offen offset:1024 lds
    s_waitcnt vmcnt(32)
    ds_read_b64_tr_b16 v[104:105], v9 offset:63488
    ds_read_b64_tr_b16 v[106:107], v9 offset:64512
    ds_read_b64_tr_b16 v[108:109], v10 offset:63488
    ds_read_b64_tr_b16 v[110:111], v10 offset:64512
    s_waitcnt vmcnt(30) lgkmcnt(4)
    v_mfma_f32_32x32x16_bf16 v[48:63], v[88:91], v[172:175], v[48:63]
    v_mfma_f32_32x32x16_bf16 v[64:79], v[92:95], v[172:175], v[64:79]
    v_mfma_f32_32x32x16_bf16 v[16:31], v[88:91], v[168:171], v[16:31]
    v_mfma_f32_32x32x16_bf16 v[32:47], v[92:95], v[168:171], v[32:47]
    s_add_u32 s67, s73, 20480
    buffer_load_dwordx4 v[232:235], v6, s[48:51], s67 offen offset:3072 sc1
    buffer_load_dwordx4 v[236:239], v7, s[48:51], s67 offen offset:3072 sc1
    s_add_u32 m0, s74, 59392
    s_add_u32 s67, s83, 0
    buffer_load_dwordx4 v4, s[44:47], s67 offen lds
    buffer_load_dwordx4 v5, s[44:47], s67 offen offset:1024 lds
    s_waitcnt vmcnt(32)
    ds_read_b64_tr_b16 v[112:113], v9 offset:0
    ds_read_b64_tr_b16 v[114:115], v9 offset:1024
    ds_read_b64_tr_b16 v[116:117], v10 offset:0
    ds_read_b64_tr_b16 v[118:119], v10 offset:1024
    s_waitcnt vmcnt(30) lgkmcnt(4)
    v_mfma_f32_32x32x16_bf16 v[48:63], v[96:99], v[180:183], v[48:63]
    v_mfma_f32_32x32x16_bf16 v[64:79], v[100:103], v[180:183], v[64:79]
    v_mfma_f32_32x32x16_bf16 v[16:31], v[96:99], v[176:179], v[16:31]
    v_mfma_f32_32x32x16_bf16 v[32:47], v[100:103], v[176:179], v[32:47]
    s_add_u32 s67, s73, 24576
    buffer_load_dwordx4 v[240:243], v6, s[48:51], s67 offen offset:2048 sc1
    buffer_load_dwordx4 v[244:247], v7, s[48:51], s67 offen offset:2048 sc1
    s_add_u32 m0, s74, 61440
    s_add_u32 s67, s83, 14336
    buffer_load_dwordx4 v4, s[44:47], s67 offen lds
    buffer_load_dwordx4 v5, s[44:47], s67 offen offset:1024 lds
    s_waitcnt vmcnt(32)
    ds_read_b64_tr_b16 v[120:121], v9 offset:2048
    ds_read_b64_tr_b16 v[122:123], v9 offset:3072
    ds_read_b64_tr_b16 v[124:125], v10 offset:2048
    ds_read_b64_tr_b16 v[126:127], v10 offset:3072
    s_waitcnt vmcnt(30) lgkmcnt(4)
    v_mfma_f32_32x32x16_bf16 v[48:63], v[104:107], v[188:191], v[48:63]
    v_mfma_f32_32x32x16_bf16 v[64:79], v[108:111], v[188:191], v[64:79]
    v_mfma_f32_32x32x16_bf16 v[16:31], v[104:107], v[184:187], v[16:31]
    v_mfma_f32_32x32x16_bf16 v[32:47], v[108:111], v[184:187], v[32:47]
    s_add_u32 s67, s73, 24576
    buffer_load_dwordx4 v[248:251], v6, s[48:51], s67 offen offset:3072 sc1
    buffer_load_dwordx4 v[252:255], v7, s[48:51], s67 offen offset:3072 sc1
    s_add_u32 m0, s74, 63488
    s_add_u32 s67, s83, 25088
    buffer_load_dwordx4 v4, s[44:47], s67 offen lds
    buffer_load_dwordx4 v5, s[44:47], s67 offen offset:1024 lds
    s_waitcnt vmcnt(32)
    ds_read_b64_tr_b16 v[128:129], v9 offset:4096
    ds_read_b64_tr_b16 v[130:131], v9 offset:5120
    ds_read_b64_tr_b16 v[132:133], v10 offset:4096
    ds_read_b64_tr_b16 v[134:135], v10 offset:5120
    s_waitcnt vmcnt(30) lgkmcnt(4)
    v_mfma_f32_32x32x16_bf16 v[48:63], v[112:115], v[196:199], v[48:63]
    v_mfma_f32_32x32x16_bf16 v[64:79], v[116:119], v[196:199], v[64:79]
    v_mfma_f32_32x32x16_bf16 v[16:31], v[112:115], v[192:195], v[16:31]
    v_mfma_f32_32x32x16_bf16 v[32:47], v[116:119], v[192:195], v[32:47]
    s_add_u32 m0, s74, 0
    s_add_u32 s67, s83, 39424
    buffer_load_dwordx4 v4, s[44:47], s67 offen lds
    buffer_load_dwordx4 v5, s[44:47], s67 offen offset:1024 lds
    s_add_u32 m0, s74, 2048
    s_add_u32 s67, s83, 50176
    buffer_load_dwordx4 v4, s[44:47], s67 offen lds
    buffer_load_dwordx4 v5, s[44:47], s67 offen offset:1024 lds
    s_waitcnt vmcnt(32)
    ds_read_b64_tr_b16 v[144:145], v9 offset:6144
    ds_read_b64_tr_b16 v[146:147], v9 offset:7168
    ds_read_b64_tr_b16 v[148:149], v10 offset:6144
    ds_read_b64_tr_b16 v[150:151], v10 offset:7168
    s_waitcnt vmcnt(30) lgkmcnt(4)
    v_mfma_f32_32x32x16_bf16 v[48:63], v[120:123], v[204:207], v[48:63]
    v_mfma_f32_32x32x16_bf16 v[64:79], v[124:127], v[204:207], v[64:79]
    v_mfma_f32_32x32x16_bf16 v[16:31], v[120:123], v[200:203], v[16:31]
    v_mfma_f32_32x32x16_bf16 v[32:47], v[124:127], v[200:203], v[32:47]
    s_add_u32 m0, s74, 4096
    s_add_u32 s67, s83, 64512
    buffer_load_dwordx4 v4, s[44:47], s67 offen lds
    buffer_load_dwordx4 v5, s[44:47], s67 offen offset:1024 lds
    s_waitcnt vmcnt(30)
    ds_read_b64_tr_b16 v[136:137], v9 offset:8192
    ds_read_b64_tr_b16 v[138:139], v9 offset:9216
    ds_read_b64_tr_b16 v[140:141], v10 offset:8192
    ds_read_b64_tr_b16 v[142:143], v10 offset:9216
    s_waitcnt vmcnt(28) lgkmcnt(4)
    v_mfma_f32_32x32x16_bf16 v[48:63], v[128:131], v[212:215], v[48:63]
    v_mfma_f32_32x32x16_bf16 v[64:79], v[132:135], v[212:215], v[64:79]
    v_mfma_f32_32x32x16_bf16 v[16:31], v[128:131], v[208:211], v[16:31]
    v_mfma_f32_32x32x16_bf16 v[32:47], v[132:135], v[208:211], v[32:47]
    s_add_u32 m0, s74, 6144
    s_add_u32 s67, s79, 0
    buffer_load_dwordx4 v4, s[44:47], s67 offen lds
    buffer_load_dwordx4 v5, s[44:47], s67 offen offset:1024 lds
    s_waitcnt vmcnt(28)
    ds_read_b64_tr_b16 v[152:153], v9 offset:53248
    ds_read_b64_tr_b16 v[154:155], v9 offset:54272
    ds_read_b64_tr_b16 v[156:157], v10 offset:53248
    ds_read_b64_tr_b16 v[158:159], v10 offset:54272
    s_waitcnt vmcnt(26) lgkmcnt(4)
    v_mfma_f32_32x32x16_bf16 v[48:63], v[144:147], v[220:223], v[48:63]
    v_mfma_f32_32x32x16_bf16 v[64:79], v[148:151], v[220:223], v[64:79]
    v_mfma_f32_32x32x16_bf16 v[16:31], v[144:147], v[216:219], v[16:31]
    v_mfma_f32_32x32x16_bf16 v[32:47], v[148:151], v[216:219], v[32:47]
    s_add_u32 m0, s74, 8192
    s_add_u32 s67, s79, 14336
    buffer_load_dwordx4 v4, s[44:47], s67 offen lds
    buffer_load_dwordx4 v5, s[44:47], s67 offen offset:1024 lds
    s_waitcnt vmcnt(26)
    ds_read_b64_tr_b16 v[80:81], v9 offset:55296
    ds_read_b64_tr_b16 v[82:83], v9 offset:56320
    ds_read_b64_tr_b16 v[84:85], v10 offset:55296
    ds_read_b64_tr_b16 v[86:87], v10 offset:56320
    s_waitcnt vmcnt(24) lgkmcnt(4)
    v_mfma_f32_32x32x16_bf16 v[48:63], v[136:139], v[228:231], v[48:63]
    v_mfma_f32_32x32x16_bf16 v[64:79], v[140:143], v[228:231], v[64:79]
    v_mfma_f32_32x32x16_bf16 v[16:31], v[136:139], v[224:227], v[16:31]
    v_mfma_f32_32x32x16_bf16 v[32:47], v[140:143], v[224:227], v[32:47]
    s_waitcnt vmcnt(22)
    ds_read_b64_tr_b16 v[160:161], v9 offset:57344
    ds_read_b64_tr_b16 v[162:163], v9 offset:58368
    ds_read_b64_tr_b16 v[164:165], v10 offset:57344
    ds_read_b64_tr_b16 v[166:167], v10 offset:58368
    s_waitcnt vmcnt(20) lgkmcnt(4)
    v_mfma_f32_32x32x16_bf16 v[48:63], v[152:155], v[236:239], v[48:63]
    v_mfma_f32_32x32x16_bf16 v[64:79], v[156:159], v[236:239], v[64:79]
    v_mfma_f32_32x32x16_bf16 v[16:31], v[152:155], v[232:235], v[16:31]
    v_mfma_f32_32x32x16_bf16 v[32:47], v[156:159], v[232:235], v[32:47]
    s_waitcnt vmcnt(16) lgkmcnt(0)
    v_mfma_f32_32x32x16_bf16 v[48:63], v[80:83], v[244:247], v[48:63]
    v_mfma_f32_32x32x16_bf16 v[64:79], v[84:87], v[244:247], v[64:79]
    v_mfma_f32_32x32x16_bf16 v[16:31], v[80:83], v[240:243], v[16:31]
    v_mfma_f32_32x32x16_bf16 v[32:47], v[84:87], v[240:243], v[32:47]
    s_waitcnt vmcnt(12) lgkmcnt(0)
    v_mfma_f32_32x32x16_bf16 v[48:63], v[160:163], v[252:255], v[48:63]
    v_mfma_f32_32x32x16_bf16 v[64:79], v[164:167], v[252:255], v[64:79]
    v_mfma_f32_32x32x16_bf16 v[16:31], v[160:163], v[248:251], v[16:31]
    v_mfma_f32_32x32x16_bf16 v[32:47], v[164:167], v[248:251], v[32:47]
    s_setprio 3
    s_xor_b32 s67, s62, 1
    s_mul_i32 s67, s67, 12288
    s_add_u32 s67, s67, 53248
    v_add_u32 v3, s67, v1
    s_xor_b32 s67, s62, 2
    s_mul_i32 s67, s67, 12288
    s_add_u32 s67, s67, 53248
    v_add_u32 v11, s67, v1
    s_lshl_b32 s67, s75, 2
    v_add_u32 v7, s67, v15
    s_lshl_b32 s67, s59, 2
    v_add_u32 v12, s67, v15
    v_mov_b32 v14, 1
    ds_write_b128 v2, v[48:51] offset:10240
    ds_write_b128 v2, v[52:55] offset:11264
    ds_write_b128 v2, v[56:59] offset:53248
    ds_write_b128 v2, v[60:63] offset:54272
    ds_write_b128 v2, v[64:67] offset:55296
    ds_write_b128 v2, v[68:71] offset:56320
    ds_write_b128 v2, v[72:75] offset:57344
    ds_write_b128 v2, v[76:79] offset:58368
    s_mul_i32 s67, s59, 12288
    v_subrev_u32 v9, s67, v9
    v_subrev_u32 v10, s67, v10
    v_add_u32 v4, 12288, v9
    v_add_u32 v5, 12288, v10
    s_waitcnt vmcnt(0)
    s_mov_b64 exec, 1
    ds_add_u32 v7, v14 offset:32
    s_mov_b64 exec, -1
    s_mov_b32 s72, 1048576
LS8:
    ds_read_b32 v13, v7 offset:32
    s_waitcnt lgkmcnt(0)
    v_readfirstlane_b32 s70, v13
    s_cmp_ge_u32 s70, 2
    s_cbranch_scc1 LS8D
    s_sleep 1
    s_sub_u32 s72, s72, 1
    s_cmp_lg_u32 s72, 0
    s_cbranch_scc1 LS8
LS8D:
    ds_read_b128 v[48:51], v3 offset:10240
    ds_read_b128 v[52:55], v3 offset:11264
    ds_read_b128 v[56:59], v3 offset:53248
    ds_read_b128 v[60:63], v3 offset:54272
    ds_read_b128 v[64:67], v3 offset:55296
    ds_read_b128 v[68:71], v3 offset:56320
    ds_read_b128 v[72:75], v3 offset:57344
    ds_read_b128 v[76:79], v3 offset:58368
    v_sub_f32 v8, 1.0, v8
    ds_read_b64_tr_b16 v[96:97], v9 offset:59392
    ds_read_b64_tr_b16 v[98:99], v9 offset:60416
    s_waitcnt lgkmcnt(9)
    v_pk_add_f32 v[16:17], v[16:17], v[48:49]
    ds_read_b64_tr_b16 v[100:101], v10 offset:59392
    ds_read_b64_tr_b16 v[102:103], v10 offset:60416
    v_pk_add_f32 v[18:19], v[18:19], v[50:51]
    ds_read_b64_tr_b16 v[104:105], v9 offset:61440
    ds_read_b64_tr_b16 v[106:107], v9 offset:62464
    s_waitcnt lgkmcnt(12)
    v_pk_add_f32 v[20:21], v[20:21], v[52:53]
    ds_read_b64_tr_b16 v[108:109], v10 offset:61440
    ds_read_b64_tr_b16 v[110:111], v10 offset:62464
    v_pk_add_f32 v[22:23], v[22:23], v[54:55]
    ds_read_b64_tr_b16 v[112:113], v9 offset:63488
    s_waitcnt lgkmcnt(14)
    ds_read_b64_tr_b16 v[114:115], v9 offset:64512
    v_pk_add_f32 v[24:25], v[24:25], v[56:57]
    s_waitcnt lgkmcnt(14)
    ds_read_b64_tr_b16 v[116:117], v10 offset:63488
    s_waitcnt lgkmcnt(14)
    ds_read_b64_tr_b16 v[118:119], v10 offset:64512
    v_pk_add_f32 v[26:27], v[26:27], v[58:59]
    s_waitcnt lgkmcnt(14)
    ds_read_b64_tr_b16 v[120:121], v9 offset:0
    s_waitcnt lgkmcnt(14)
    ds_read_b64_tr_b16 v[122:123], v9 offset:1024
    v_pk_add_f32 v[28:29], v[28:29], v[60:61]
    s_waitcnt lgkmcnt(14)
    ds_read_b64_tr_b16 v[124:125], v10 offset:0
    s_waitcnt lgkmcnt(14)
    ds_read_b64_tr_b16 v[126:127], v10 offset:1024
    v_pk_add_f32 v[30:31], v[30:31], v[62:63]
    s_waitcnt lgkmcnt(14)
    ds_read_b64_tr_b16 v[128:129], v9 offset:2048
    s_waitcnt lgkmcnt(14)
    ds_read_b64_tr_b16 v[130:131], v9 offset:3072
    v_pk_add_f32 v[32:33], v[32:33], v[64:65]
    s_waitcnt lgkmcnt(14)
    ds_read_b64_tr_b16 v[132:133], v10 offset:2048
    s_waitcnt lgkmcnt(14)
    ds_read_b64_tr_b16 v[134:135], v10 offset:3072
    v_pk_add_f32 v[34:35], v[34:35], v[66:67]
    s_waitcnt lgkmcnt(14)
    ds_read_b64_tr_b16 v[136:137], v9 offset:4096
    s_waitcnt lgkmcnt(14)
    ds_read_b64_tr_b16 v[138:139], v9 offset:5120
    v_pk_add_f32 v[36:37], v[36:37], v[68:69]
    s_waitcnt lgkmcnt(14)
    ds_read_b64_tr_b16 v[140:141], v10 offset:4096
    s_waitcnt lgkmcnt(14)
    ds_read_b64_tr_b16 v[142:143], v10 offset:5120
    v_pk_add_f32 v[38:39], v[38:39], v[70:71]
    s_waitcnt lgkmcnt(14)
    ds_read_b64_tr_b16 v[144:145], v9 offset:6144
    s_waitcnt lgkmcnt(14)
    ds_read_b64_tr_b16 v[146:147], v9 offset:7168
    v_pk_add_f32 v[40:41], v[40:41], v[72:73]
    s_waitcnt lgkmcnt(14)
    ds_read_b64_tr_b16 v[148:149], v10 offset:6144
    s_waitcnt lgkmcnt(14)
    ds_read_b64_tr_b16 v[150:151], v10 offset:7168
    v_pk_add_f32 v[42:43], v[42:43], v[74:75]
    s_waitcnt lgkmcnt(14)
    ds_read_b64_tr_b16 v[152:153], v9 offset:8192
    s_waitcnt lgkmcnt(14)
    ds_read_b64_tr_b16 v[154:155], v9 offset:9216
    v_pk_add_f32 v[44:45], v[44:45], v[76:77]
    s_waitcnt lgkmcnt(14)
    ds_read_b64_tr_b16 v[156:157], v10 offset:8192
    s_waitcnt lgkmcnt(14)
    ds_read_b64_tr_b16 v[158:159], v10 offset:9216
    v_pk_add_f32 v[46:47], v[46:47], v[78:79]
    s_waitcnt lgkmcnt(14)
    ds_read_b64_tr_b16 v[160:161], v4 offset:59392
    s_waitcnt lgkmcnt(14)
    ds_read_b64_tr_b16 v[162:163], v4 offset:60416
    v_pk_mul_f32 v[16:17], v[16:17], v[8:9] op_sel_hi:[1,0]
    s_waitcnt lgkmcnt(14)
    ds_read_b64_tr_b16 v[164:165], v5 offset:59392
    s_waitcnt lgkmcnt(14)
    ds_read_b64_tr_b16 v[166:167], v5 offset:60416
    v_pk_mul_f32 v[18:19], v[18:19], v[8:9] op_sel_hi:[1,0]
    s_waitcnt lgkmcnt(14)
    ds_read_b64_tr_b16 v[168:169], v4 offset:61440
    s_waitcnt lgkmcnt(14)
    ds_read_b64_tr_b16 v[170:171], v4 offset:62464
    v_pk_mul_f32 v[20:21], v[20:21], v[8:9] op_sel_hi:[1,0]
    s_waitcnt lgkmcnt(14)
    ds_read_b64_tr_b16 v[172:173], v5 offset:61440
    s_waitcnt lgkmcnt(14)
    ds_read_b64_tr_b16 v[174:175], v5 offset:62464
    v_pk_mul_f32 v[22:23], v[22:23], v[8:9] op_sel_hi:[1,0]
    s_waitcnt lgkmcnt(14)
    ds_read_b64_tr_b16 v[176:177], v4 offset:63488
    s_waitcnt lgkmcnt(14)
    ds_read_b64_tr_b16 v[178:179], v4 offset:64512
    v_pk_mul_f32 v[24:25], v[24:25], v[8:9] op_sel_hi:[1,0]
    s_waitcnt lgkmcnt(14)
    ds_read_b64_tr_b16 v[180:181], v5 offset:63488
    s_waitcnt lgkmcnt(14)
    ds_read_b64_tr_b16 v[182:183], v5 offset:64512
    v_pk_mul_f32 v[26:27], v[26:27], v[8:9] op_sel_hi:[1,0]
    s_waitcnt lgkmcnt(14)
    ds_read_b64_tr_b16 v[184:185], v4 offset:0
    s_waitcnt lgkmcnt(14)
    ds_read_b64_tr_b16 v[186:187], v4 offset:1024
    v_pk_mul_f32 v[28:29], v[28:29], v[8:9] op_sel_hi:[1,0]
    s_waitcnt lgkmcnt(14)
    ds_read_b64_tr_b16 v[188:189], v5 offset:0
    s_waitcnt lgkmcnt(14)
    ds_read_b64_tr_b16 v[190:191], v5 offset:1024
    v_pk_mul_f32 v[30:31], v[30:31], v[8:9] op_sel_hi:[1,0]
    s_waitcnt lgkmcnt(14)
    ds_read_b64_tr_b16 v[192:193], v4 offset:2048
    s_waitcnt lgkmcnt(14)
    ds_read_b64_tr_b16 v[194:195], v4 offset:3072
    v_pk_mul_f32 v[32:33], v[32:33], v[8:9] op_sel_hi:[1,0]
    s_waitcnt lgkmcnt(14)
    ds_read_b64_tr_b16 v[196:197], v5 offset:2048
    s_waitcnt lgkmcnt(14)
    ds_read_b64_tr_b16 v[198:199], v5 offset:3072
    v_pk_mul_f32 v[34:35], v[34:35], v[8:9] op_sel_hi:[1,0]
    s_waitcnt lgkmcnt(14)
    ds_read_b64_tr_b16 v[200:201], v4 offset:4096
    s_waitcnt lgkmcnt(14)
    ds_read_b64_tr_b16 v[202:203], v4 offset:5120
    v_pk_mul_f32 v[36:37], v[36:37], v[8:9] op_sel_hi:[1,0]
    s_waitcnt lgkmcnt(14)
    ds_read_b64_tr_b16 v[204:205], v5 offset:4096
    s_waitcnt lgkmcnt(14)
    ds_read_b64_tr_b16 v[206:207], v5 offset:5120
    v_pk_mul_f32 v[38:39], v[38:39], v[8:9] op_sel_hi:[1,0]
    s_waitcnt lgkmcnt(14)
    ds_read_b64_tr_b16 v[208:209], v4 offset:6144
    s_waitcnt lgkmcnt(14)
    ds_read_b64_tr_b16 v[210:211], v4 offset:7168
    v_pk_mul_f32 v[40:41], v[40:41], v[8:9] op_sel_hi:[1,0]
    s_waitcnt lgkmcnt(14)
    ds_read_b64_tr_b16 v[212:213], v5 offset:6144
    s_waitcnt lgkmcnt(14)
    ds_read_b64_tr_b16 v[214:215], v5 offset:7168
    v_pk_mul_f32 v[42:43], v[42:43], v[8:9] op_sel_hi:[1,0]
    s_waitcnt lgkmcnt(14)
    ds_read_b64_tr_b16 v[216:217], v4 offset:8192
    s_waitcnt lgkmcnt(14)
    ds_read_b64_tr_b16 v[218:219], v4 offset:9216
    v_pk_mul_f32 v[44:45], v[44:45], v[8:9] op_sel_hi:[1,0]
    s_waitcnt lgkmcnt(14)
    ds_read_b64_tr_b16 v[220:221], v5 offset:8192
    s_waitcnt lgkmcnt(14)
    ds_read_b64_tr_b16 v[222:223], v5 offset:9216
    v_pk_mul_f32 v[46:47], v[46:47], v[8:9] op_sel_hi:[1,0]
    s_mov_b64 exec, 1
    s_waitcnt lgkmcnt(14)
    ds_add_u32 v7, v14 offset:32
    s_mov_b64 exec, -1
    s_mov_b32 s52, s24
    s_mov_b32 s53, s25
    s_mov_b32 s54, 1835008
    s_mov_b32 s55, 0x00020000
    s_lshl_b32 s83, s75, 14
    s_add_u32 s83, s83, 114688
    s_add_u32 s80, s83, 4096
    s_add_u32 s81, s83, 8192
    s_add_u32 s82, s83, 12288
    s_mov_b32 s79, s83
    v_and_b32 v3, 31, v0
    v_mul_u32_u24 v3, 896, v3
    v_lshrrev_b32 v13, 5, v0
    v_lshl_add_u32 v3, v13, 4, v3
    s_mul_i32 s69, s78, 28672
    s_lshl_b32 s68, s76, 6
    s_add_u32 s69, s69, s68
    s_setprio 0
    s_mov_b32 s72, 1048576
LS9:
    ds_read_b32 v13, v15 offset:12
    s_waitcnt lgkmcnt(0)
    v_readfirstlane_b32 s70, v13
    s_cmp_ge_u32 s70, 4
    s_cbranch_scc1 LS9D
    s_sleep 2
    s_sub_u32 s72, s72, 1
    s_cmp_lg_u32 s72, 0
    s_cbranch_scc1 LS9
LS9D:
    s_mov_b32 s72, 1048576
LS10:
    ds_read_b32 v13, v7 offset:32
    s_waitcnt lgkmcnt(0)
    v_readfirstlane_b32 s70, v13
    s_cmp_ge_u32 s70, 4
    s_cbranch_scc1 LS10D
    s_sub_u32 s72, s72, 1
    s_cmp_lg_u32 s72, 0
    s_cbranch_scc1 LS10
LS10D:
    s_mov_b64 s[56:57], -1
    s_mov_b32 s72, 65536
    s_movk_i32 s71, 0xff
    buffer_load_dwordx4 v[248:251], v6, s[48:51], s82 offen offset:2048 sc1
    buffer_load_dwordx4 v[252:255], v6, s[48:51], s82 offen offset:3072 sc1
    buffer_load_dwordx4 v[48:51], v6, s[48:51], s79 offen offset:0 sc1
    buffer_load_dwordx4 v[52:55], v6, s[48:51], s79 offen offset:1024 sc1
    buffer_load_dwordx4 v[56:59], v6, s[48:51], s79 offen offset:2048 sc1
    buffer_load_dwordx4 v[60:63], v6, s[48:51], s79 offen offset:3072 sc1
    buffer_load_dwordx4 v[64:67], v6, s[48:51], s80 offen offset:0 sc1
    buffer_load_dwordx4 v[68:71], v6, s[48:51], s80 offen offset:1024 sc1
    buffer_load_dwordx4 v[72:75], v6, s[48:51], s80 offen offset:2048 sc1
    buffer_load_dwordx4 v[76:79], v6, s[48:51], s80 offen offset:3072 sc1
    buffer_load_dwordx4 v[224:227], v6, s[48:51], s81 offen offset:0 sc1
    buffer_load_dwordx4 v[228:231], v6, s[48:51], s81 offen offset:1024 sc1
    buffer_load_dwordx4 v[232:235], v6, s[48:51], s81 offen offset:2048 sc1
    buffer_load_dwordx4 v[236:239], v6, s[48:51], s81 offen offset:3072 sc1
    buffer_load_dwordx4 v[240:243], v6, s[48:51], s82 offen offset:0 sc1
    buffer_load_dwordx4 v[244:247], v6, s[48:51], s82 offen offset:1024 sc1
O_PASS:
    s_bitcmp0_b32 s71, 7
    s_cbranch_scc1 O_SK7
    s_waitcnt vmcnt(14)
    v_max3_u32 v13, v248, v249, v250
    v_max3_u32 v13, v13, v251, v252
    v_max3_u32 v13, v13, v253, v254
    v_max_u32 v13, v13, v255
    v_cmp_eq_u32 vcc, -1, v13
    s_and_b64 vcc, vcc, s[56:57]
    s_cbranch_scc1 O_SK7
    v_mfma_f32_32x32x16_bf16 v[32:47], v[212:215], v[248:251], v[32:47]
    s_bitset0_b32 s71, 7
    v_mfma_f32_32x32x16_bf16 v[16:31], v[208:211], v[248:251], v[16:31]
    v_mfma_f32_32x32x16_bf16 v[32:47], v[220:223], v[252:255], v[32:47]
    v_mfma_f32_32x32x16_bf16 v[16:31], v[216:219], v[252:255], v[16:31]
O_SK7:
    s_bitcmp0_b32 s71, 0
    s_cbranch_scc1 O_SK0
    s_waitcnt vmcnt(12)
    v_max3_u32 v13, v48, v49, v50
    v_max3_u32 v13, v13, v51, v52
    v_max3_u32 v13, v13, v53, v54
    v_max_u32 v13, v13, v55
    v_cmp_eq_u32 vcc, -1, v13
    s_and_b64 vcc, vcc, s[56:57]
    s_cbranch_scc1 O_SK0
    v_mfma_f32_32x32x16_bf16 v[32:47], v[100:103], v[48:51], v[32:47]
    s_bitset0_b32 s71, 0
    v_mfma_f32_32x32x16_bf16 v[16:31], v[96:99], v[48:51], v[16:31]
    v_mfma_f32_32x32x16_bf16 v[32:47], v[108:111], v[52:55], v[32:47]
    v_mfma_f32_32x32x16_bf16 v[16:31], v[104:107], v[52:55], v[16:31]
O_SK0:
    s_bitcmp0_b32 s71, 1
    s_cbranch_scc1 O_SK1
    s_waitcnt vmcnt(10)
    v_max3_u32 v13, v56, v57, v58
    v_max3_u32 v13, v13, v59, v60
    v_max3_u32 v13, v13, v61, v62
    v_max_u32 v13, v13, v63
    v_cmp_eq_u32 vcc, -1, v13
    s_and_b64 vcc, vcc, s[56:57]
    s_cbranch_scc1 O_SK1
    v_mfma_f32_32x32x16_bf16 v[32:47], v[116:119], v[56:59], v[32:47]
    s_bitset0_b32 s71, 1
    v_mfma_f32_32x32x16_bf16 v[16:31], v[112:115], v[56:59], v[16:31]
    v_mfma_f32_32x32x16_bf16 v[32:47], v[124:127], v[60:63], v[32:47]
    v_mfma_f32_32x32x16_bf16 v[16:31], v[120:123], v[60:63], v[16:31]
O_SK1:
    s_bitcmp0_b32 s71, 2
    s_cbranch_scc1 O_SK2
    s_waitcnt vmcnt(8)
    v_max3_u32 v13, v64, v65, v66
    v_max3_u32 v13, v13, v67, v68
    v_max3_u32 v13, v13, v69, v70
    v_max_u32 v13, v13, v71
    v_cmp_eq_u32 vcc, -1, v13
    s_and_b64 vcc, vcc, s[56:57]
    s_cbranch_scc1 O_SK2
    v_mfma_f32_32x32x16_bf16 v[32:47], v[132:135], v[64:67], v[32:47]
    s_bitset0_b32 s71, 2
    v_mfma_f32_32x32x16_bf16 v[16:31], v[128:131], v[64:67], v[16:31]
    v_mfma_f32_32x32x16_bf16 v[32:47], v[140:143], v[68:71], v[32:47]
    v_mfma_f32_32x32x16_bf16 v[16:31], v[136:139], v[68:71], v[16:31]
O_SK2:
    s_bitcmp0_b32 s71, 3
    s_cbranch_scc1 O_SK3
    s_waitcnt vmcnt(6)
    v_max3_u32 v13, v72, v73, v74
    v_max3_u32 v13, v13, v75, v76
    v_max3_u32 v13, v13, v77, v78
    v_max_u32 v13, v13, v79
    v_cmp_eq_u32 vcc, -1, v13
    s_and_b64 vcc, vcc, s[56:57]
    s_cbranch_scc1 O_SK3
    v_mfma_f32_32x32x16_bf16 v[32:47], v[148:151], v[72:75], v[32:47]
    s_bitset0_b32 s71, 3
    v_mfma_f32_32x32x16_bf16 v[16:31], v[144:147], v[72:75], v[16:31]
    v_mfma_f32_32x32x16_bf16 v[32:47], v[156:159], v[76:79], v[32:47]
    v_mfma_f32_32x32x16_bf16 v[16:31], v[152:155], v[76:79], v[16:31]
O_SK3:
    s_bitcmp0_b32 s71, 4
    s_cbranch_scc1 O_SK4
    s_waitcnt vmcnt(4)
    v_max3_u32 v13, v224, v225, v226
    v_max3_u32 v13, v13, v227, v228
    v_max3_u32 v13, v13, v229, v230
    v_max_u32 v13, v13, v231
    v_cmp_eq_u32 vcc, -1, v13
    s_and_b64 vcc, vcc, s[56:57]
    s_cbranch_scc1 O_SK4
    v_mfma_f32_32x32x16_bf16 v[32:47], v[164:167], v[224:227], v[32:47]
    s_bitset0_b32 s71, 4
    v_mfma_f32_32x32x16_bf16 v[16:31], v[160:163], v[224:227], v[16:31]
    v_mfma_f32_32x32x16_bf16 v[32:47], v[172:175], v[228:231], v[32:47]
    v_mfma_f32_32x32x16_bf16 v[16:31], v[168:171], v[228:231], v[16:31]
O_SK4:
    s_bitcmp0_b32 s71, 5
    s_cbranch_scc1 O_SK5
    s_waitcnt vmcnt(2)
    v_max3_u32 v13, v232, v233, v234
    v_max3_u32 v13, v13, v235, v236
    v_max3_u32 v13, v13, v237, v238
    v_max_u32 v13, v13, v239
    v_cmp_eq_u32 vcc, -1, v13
    s_and_b64 vcc, vcc, s[56:57]
    s_cbranch_scc1 O_SK5
    v_mfma_f32_32x32x16_bf16 v[32:47], v[180:183], v[232:235], v[32:47]
    s_bitset0_b32 s71, 5
    v_mfma_f32_32x32x16_bf16 v[16:31], v[176:179], v[232:235], v[16:31]
    v_mfma_f32_32x32x16_bf16 v[32:47], v[188:191], v[236:239], v[32:47]
    v_mfma_f32_32x32x16_bf16 v[16:31], v[184:187], v[236:239], v[16:31]
O_SK5:
    s_bitcmp0_b32 s71, 6
    s_cbranch_scc1 O_SK6
    s_waitcnt vmcnt(0)
    v_max3_u32 v13, v240, v241, v242
    v_max3_u32 v13, v13, v243, v244
    v_max3_u32 v13, v13, v245, v246
    v_max_u32 v13, v13, v247
    v_cmp_eq_u32 vcc, -1, v13
    s_and_b64 vcc, vcc, s[56:57]
    s_cbranch_scc1 O_SK6
    v_mfma_f32_32x32x16_bf16 v[32:47], v[196:199], v[240:243], v[32:47]
    s_bitset0_b32 s71, 6
    v_mfma_f32_32x32x16_bf16 v[16:31], v[192:195], v[240:243], v[16:31]
    v_mfma_f32_32x32x16_bf16 v[32:47], v[204:207], v[244:247], v[32:47]
    v_mfma_f32_32x32x16_bf16 v[16:31], v[200:203], v[244:247], v[16:31]
O_SK6:
    s_cmp_eq_u32 s71, 0
    s_cbranch_scc1 O_DONE
    s_bitcmp0_b32 s71, 7
    s_cbranch_scc1 O_NL7
    buffer_load_dwordx4 v[248:251], v6, s[48:51], s82 offen offset:2048 sc1
    buffer_load_dwordx4 v[252:255], v6, s[48:51], s82 offen offset:3072 sc1
O_NL7:
    s_bitcmp0_b32 s71, 0
    s_cbranch_scc1 O_NL0
    buffer_load_dwordx4 v[48:51], v6, s[48:51], s79 offen offset:0 sc1
    buffer_load_dwordx4 v[52:55], v6, s[48:51], s79 offen offset:1024 sc1
O_NL0:
    s_bitcmp0_b32 s71, 1
    s_cbranch_scc1 O_NL1
    buffer_load_dwordx4 v[56:59], v6, s[48:51], s79 offen offset:2048 sc1
    buffer_load_dwordx4 v[60:63], v6, s[48:51], s79 offen offset:3072 sc1
O_NL1:
    s_bitcmp0_b32 s71, 2
    s_cbranch_scc1 O_NL2
    buffer_load_dwordx4 v[64:67], v6, s[48:51], s80 offen offset:0 sc1
    buffer_load_dwordx4 v[68:71], v6, s[48:51], s80 offen offset:1024 sc1
O_NL2:
    s_bitcmp0_b32 s71, 3
    s_cbranch_scc1 O_NL3
    buffer_load_dwordx4 v[72:75], v6, s[48:51], s80 offen offset:2048 sc1
    buffer_load_dwordx4 v[76:79], v6, s[48:51], s80 offen offset:3072 sc1
O_NL3:
    s_bitcmp0_b32 s71, 4
    s_cbranch_scc1 O_NL4
    buffer_load_dwordx4 v[224:227], v6, s[48:51], s81 offen offset:0 sc1
    buffer_load_dwordx4 v[228:231], v6, s[48:51], s81 offen offset:1024 sc1
O_NL4:
    s_bitcmp0_b32 s71, 5
    s_cbranch_scc1 O_NL5
    buffer_load_dwordx4 v[232:235], v6, s[48:51], s81 offen offset:2048 sc1
    buffer_load_dwordx4 v[236:239], v6, s[48:51], s81 offen offset:3072 sc1
O_NL5:
    s_bitcmp0_b32 s71, 6
    s_cbranch_scc1 O_NL6
    buffer_load_dwordx4 v[240:243], v6, s[48:51], s82 offen offset:0 sc1
    buffer_load_dwordx4 v[244:247], v6, s[48:51], s82 offen offset:1024 sc1
O_NL6:
    s_sub_u32 s72, s72, 1
    s_cmp_gt_i32 s72, 0
    s_cselect_b64 s[56:57], -1, 0
    s_waitcnt vmcnt(0)
    s_branch O_PASS
O_DONE:
    s_nop 7
    s_nop 1
    ds_write_b128 v2, v[32:35] offset:10240
    ds_write_b128 v2, v[36:39] offset:11264
    ds_write_b128 v2, v[40:43] offset:53248
    ds_write_b128 v2, v[44:47] offset:54272
    s_mov_b64 exec, 1
    ds_add_u32 v12, v14 offset:40
    s_mov_b64 exec, -1
    s_mov_b32 s72, 1048576
LS11:
    ds_read_b32 v13, v12 offset:40
    s_waitcnt lgkmcnt(0)
    v_readfirstlane_b32 s70, v13
    s_cmp_ge_u32 s70, 2
    s_cbranch_scc1 LS11D
    s_sub_u32 s72, s72, 1
    s_cmp_lg_u32 s72, 0
    s_cbranch_scc1 LS11
LS11D:
    ds_read_b128 v[32:35], v11 offset:10240
    ds_read_b128 v[36:39], v11 offset:11264
    ds_read_b128 v[40:43], v11 offset:53248
    ds_read_b128 v[44:47], v11 offset:54272
    s_nop 2
    s_waitcnt lgkmcnt(3)
    v_pk_add_f32 v[16:17], v[16:17], v[32:33]
    v_pk_add_f32 v[18:19], v[18:19], v[34:35]
    v_cvt_pk_bf16_f32 v48, v16, v17
    v_cvt_pk_bf16_f32 v49, v18, v19
    s_waitcnt lgkmcnt(2)
    v_pk_add_f32 v[20:21], v[20:21], v[36:37]
    v_pk_add_f32 v[22:23], v[22:23], v[38:39]
    v_cvt_pk_bf16_f32 v50, v20, v21
    v_cvt_pk_bf16_f32 v51, v22, v23
    s_waitcnt lgkmcnt(1)
    v_pk_add_f32 v[24:25], v[24:25], v[40:41]
    v_pk_add_f32 v[26:27], v[26:27], v[42:43]
    v_cvt_pk_bf16_f32 v52, v24, v25
    v_cvt_pk_bf16_f32 v53, v26, v27
    s_waitcnt lgkmcnt(0)
    v_pk_add_f32 v[28:29], v[28:29], v[44:45]
    v_pk_add_f32 v[30:31], v[30:31], v[46:47]
    v_cvt_pk_bf16_f32 v54, v28, v29
    v_cvt_pk_bf16_f32 v55, v30, v31
    v_permlane32_swap_b32 v48, v50
    v_permlane32_swap_b32 v49, v51
    buffer_store_dwordx4 v[48:51], v3, s[52:55], s69 offen
    v_permlane32_swap_b32 v52, v54
    v_permlane32_swap_b32 v53, v55
    buffer_store_dwordx4 v[52:55], v3, s[52:55], s69 offen offset:32
    s_endpgm
B_SPARE:
    s_cmp_eq_u32 s64, 0
    s_cselect_b32 s40, s8, s10
    s_cselect_b32 s41, s9, s11
    s_mov_b32 s42, 25088
    s_mov_b32 s43, 0x00020000
    s_mov_b32 s56, s22
    s_mov_b32 s57, s23
    s_mov_b32 s58, 896
    s_mov_b32 s59, 0x00020000
    s_mov_b32 m0, 143360
    s_nop 0
    buffer_load_dwordx4 v1, s[56:59], 0 offen lds
    s_add_u32 m0, s77, 114688
    s_movk_i32 s67, 0
    buffer_load_dwordx4 v11, s[40:43], s67 offen lds
    s_add_u32 m0, s76, 0
    s_movk_i32 s67, 0
    buffer_load_dwordx4 v2, s[32:35], s67 offen offset:0 lds
    buffer_load_dwordx4 v3, s[32:35], s67 offen offset:1024 lds
    buffer_load_dwordx4 v4, s[32:35], s67 offen offset:2048 lds
    buffer_load_dwordx4 v5, s[32:35], s67 offen offset:3072 lds
    s_add_u32 m0, s77, 118784
    s_movk_i32 s67, 3584
    buffer_load_dwordx4 v11, s[40:43], s67 offen lds
    s_add_u32 m0, s76, 16384
    s_movk_i32 s67, 128
    buffer_load_dwordx4 v2, s[32:35], s67 offen offset:0 lds
    buffer_load_dwordx4 v3, s[32:35], s67 offen offset:1024 lds
    buffer_load_dwordx4 v4, s[32:35], s67 offen offset:2048 lds
    buffer_load_dwordx4 v5, s[32:35], s67 offen offset:3072 lds
    s_add_u32 m0, s77, 122880
    s_movk_i32 s67, 7168
    buffer_load_dwordx4 v11, s[40:43], s67 offen lds
    s_add_u32 m0, s76, 32768
    s_movk_i32 s67, 256
    buffer_load_dwordx4 v2, s[32:35], s67 offen offset:0 lds
    buffer_load_dwordx4 v3, s[32:35], s67 offen offset:1024 lds
    buffer_load_dwordx4 v4, s[32:35], s67 offen offset:2048 lds
    buffer_load_dwordx4 v5, s[32:35], s67 offen offset:3072 lds
    s_waitcnt vmcnt(10)
    s_barrier
    s_add_u32 m0, s77, 126976
    s_movk_i32 s67, 10752
    buffer_load_dwordx4 v11, s[40:43], s67 offen lds
    s_add_u32 m0, s76, 49152
    s_movk_i32 s67, 384
    buffer_load_dwordx4 v2, s[32:35], s67 offen offset:0 lds
    buffer_load_dwordx4 v3, s[32:35], s67 offen offset:1024 lds
    buffer_load_dwordx4 v4, s[32:35], s67 offen offset:2048 lds
    buffer_load_dwordx4 v5, s[32:35], s67 offen offset:3072 lds
    s_waitcnt vmcnt(10)
    s_barrier
    s_add_u32 m0, s77, 131072
    s_movk_i32 s67, 14336
    buffer_load_dwordx4 v11, s[40:43], s67 offen lds
    s_add_u32 m0, s76, 65536
    s_movk_i32 s67, 512
    buffer_load_dwordx4 v2, s[32:35], s67 offen offset:0 lds
    buffer_load_dwordx4 v3, s[32:35], s67 offen offset:1024 lds
    buffer_load_dwordx4 v4, s[32:35], s67 offen offset:2048 lds
    buffer_load_dwordx4 v5, s[32:35], s67 offen offset:3072 lds
    s_waitcnt vmcnt(10)
    s_barrier
    s_add_u32 m0, s77, 135168
    s_movk_i32 s67, 17920
    buffer_load_dwordx4 v11, s[40:43], s67 offen lds
    s_add_u32 m0, s76, 81920
    s_movk_i32 s67, 640
    buffer_load_dwordx4 v2, s[32:35], s67 offen offset:0 lds
    buffer_load_dwordx4 v3, s[32:35], s67 offen offset:1024 lds
    buffer_load_dwordx4 v4, s[32:35], s67 offen offset:2048 lds
    buffer_load_dwordx4 v5, s[32:35], s67 offen offset:3072 lds
    s_waitcnt vmcnt(10)
    s_barrier
    s_add_u32 m0, s77, 139264
    s_movk_i32 s67, 21504
    buffer_load_dwordx4 v11, s[40:43], s67 offen lds
    s_add_u32 m0, s76, 98304
    s_movk_i32 s67, 768
    buffer_load_dwordx4 v2, s[32:35], s67 offen offset:0 lds
    buffer_load_dwordx4 v3, s[32:35], s67 offen offset:1024 lds
    buffer_load_dwordx4 v4, s[32:35], s67 offen offset:2048 lds
    buffer_load_dwordx4 v5, s[32:35], s67 offen offset:3072 lds
    s_waitcnt vmcnt(10)
    s_barrier
    s_waitcnt vmcnt(5)
    s_barrier
    s_waitcnt vmcnt(0)
    s_barrier
    s_barrier
    s_add_u32 m0, s77, 114688
    s_mov_b32 s67, 0
    buffer_load_dwordx4 v10, s[36:39], s67 offen lds
    s_add_u32 m0, s77, 118784
    s_mov_b32 s67, 57344
    buffer_load_dwordx4 v10, s[36:39], s67 offen lds
    s_add_u32 m0, s77, 122880
    s_mov_b32 s67, 114688
    buffer_load_dwordx4 v10, s[36:39], s67 offen lds
    s_add_u32 m0, s77, 126976
    s_mov_b32 s67, 172032
    buffer_load_dwordx4 v10, s[36:39], s67 offen lds
    s_add_u32 m0, s77, 131072
    s_mov_b32 s67, 229376
    buffer_load_dwordx4 v10, s[36:39], s67 offen lds
    s_add_u32 m0, s77, 135168
    s_mov_b32 s67, 286720
    buffer_load_dwordx4 v10, s[36:39], s67 offen lds
    s_add_u32 m0, s77, 139264
    s_mov_b32 s67, 344064
    buffer_load_dwordx4 v10, s[36:39], s67 offen lds
    s_mov_b32 s44, s20
    s_mov_b32 s45, s21
    s_mov_b32 s46, 1605632
    s_mov_b32 s47, 0x00020000
    s_mov_b32 s56, s12
    s_mov_b32 s57, s13
    s_mov_b32 s58, 401408
    s_mov_b32 s59, 0x00020000
    s_lshl_b32 s68, s60, 1
    s_add_u32 s68, s68, s64
    s_lshl_b32 s68, s68, 2
    s_add_u32 s68, s68, s62
    s_mul_i32 s69, s68, 3136
    s_mul_i32 s68, s68, 12544
    buffer_load_dwordx4 v[64:67], v1, s[44:47], s68 offen offset:0
    buffer_load_dwordx4 v[64:67], v1, s[44:47], s68 offen offset:1024
    buffer_load_dwordx4 v[64:67], v1, s[44:47], s68 offen offset:2048
    buffer_load_dwordx4 v[64:67], v1, s[44:47], s68 offen offset:3072
    s_add_u32 s68, s68, 4096
    buffer_load_dwordx4 v[64:67], v1, s[44:47], s68 offen offset:0
    buffer_load_dwordx4 v[64:67], v1, s[44:47], s68 offen offset:1024
    buffer_load_dwordx4 v[64:67], v1, s[44:47], s68 offen offset:2048
    buffer_load_dwordx4 v[64:67], v1, s[44:47], s68 offen offset:3072
    s_add_u32 s68, s68, 4096
    buffer_load_dwordx4 v[64:67], v1, s[44:47], s68 offen offset:0
    buffer_load_dwordx4 v[64:67], v1, s[44:47], s68 offen offset:1024
    buffer_load_dwordx4 v[64:67], v1, s[44:47], s68 offen offset:2048
    buffer_load_dwordx4 v[64:67], v1, s[44:47], s68 offen offset:3072
    s_add_u32 s68, s68, 4096
    buffer_load_dwordx4 v[64:67], v1, s[44:47], s68 offen offset:0
    buffer_load_dwordx4 v[64:67], v1, s[56:59], s69 offen offset:0
    buffer_load_dwordx4 v[64:67], v1, s[56:59], s69 offen offset:1024
    buffer_load_dwordx4 v[64:67], v1, s[56:59], s69 offen offset:2048
    buffer_load_dwordx4 v[64:67], v1, s[56:59], s69 offen offset:3072
    s_waitcnt vmcnt(17)
    s_barrier
    s_endpgm
AW:
    s_setprio 3
    v_lshrrev_b32 v13, 5, v0
    v_bfe_u32 v14, v0, 2, 2
    v_bfe_u32 v15, v0, 4, 1
    v_lshlrev_b32 v15, 5, v15
    v_and_b32 v12, 3, v0
    v_lshl_add_u32 v15, v12, 3, v15
    v_lshl_add_u32 v12, v13, 3, v14
    s_lshl_b32 s67, s62, 12
    v_and_b32 v10, 31, v0
    v_lshlrev_b32 v10, 7, v10
    v_add_u32 v10, s67, v10
    v_bfe_u32 v11, v0, 1, 3
    v_xor_b32 v11, v13, v11
    v_xor_b32 v2, 0, v11
    v_lshl_add_u32 v2, v2, 4, v10
    v_xor_b32 v3, 2, v11
    v_lshl_add_u32 v3, v3, 4, v10
    v_xor_b32 v4, 4, v11
    v_lshl_add_u32 v4, v4, 4, v10
    v_xor_b32 v5, 6, v11
    v_lshl_add_u32 v5, v5, 4, v10
    s_getpc_b64 s[80:81]
PCREF:
    s_sub_u32 s80, s80, PCREF-gated_mix__grouped_kv_mqa__glu_gated_bilinear__prompt_kernel
    s_subb_u32 s81, s81, 0
    s_mov_b32 s82, KEND-gated_mix__grouped_kv_mqa__glu_gated_bilinear__prompt_kernel
    s_mov_b32 s83, 0x00020000
    s_lshl_b32 s67, s62, 5
    s_add_u32 s67, s67, s69
    s_lshl_b32 s67, s67, 10
    buffer_load_dwordx4 v[216:219], v1, s[80:83], s67 offen
    v_mov_b32 v248, 0
    v_lshlrev_b32 v16, 2, v0
    v_add_u32 v16, 159744, v16
    s_waitcnt lgkmcnt(0)
    ds_write_b32 v16, v248
    s_mov_b32 s48, s28
    s_mov_b32 s49, s29
    s_mov_b32 s50, 16777216
    s_mov_b32 s51, 0x00020000
    s_mov_b32 s56, s26
    s_mov_b32 s57, s27
    s_mov_b32 s58, 256
    s_mov_b32 s59, 0x00020000
    s_or_b32 s67, s2, s62
    s_cmp_lg_u32 s67, 0
    s_cbranch_scc1 A_NONONCE
    s_mov_b32 s67, 274432
    buffer_load_dword v17, v248, s[48:51], s67 offen sc1
    s_waitcnt vmcnt(0)
    v_add_u32 v17, 1, v17
    v_max_u32 v17, 1, v17
    s_mov_b64 exec, 1
    buffer_store_dword v17, v248, s[56:59], 0 offen sc1
    buffer_store_dword v17, v248, s[48:51], s67 offen sc1
    s_mov_b64 exec, -1
A_NONONCE:
    s_lshl_b32 s67, s62, 16
    s_add_u32 s52, s28, s67
    s_addc_u32 s53, s29, 0
    s_mov_b32 s54, 65536
    s_mov_b32 s55, 0x00020000
    s_lshl_b32 s74, s60, 2
    s_add_u32 s74, s74, s62
    s_lshl_b32 s69, s74, 7
    s_add_u32 s68, s69, 278528
    s_add_u32 s69, s69, 262144
    s_movk_i32 s73, 4096
    s_add_u32 s67, s62, 1
    s_and_b32 s67, s67, 3
    s_mul_i32 s40, s67, 12288
    s_add_u32 s80, s40, 63488
    s_add_u32 s40, s40, 0
    s_add_u32 s67, s62, 2
    s_and_b32 s67, s67, 3
    s_mul_i32 s41, s67, 12288
    s_add_u32 s81, s41, 63488
    s_add_u32 s41, s41, 4096
    s_add_u32 s67, s62, 3
    s_and_b32 s67, s67, 3
    s_mul_i32 s42, s67, 12288
    s_add_u32 s82, s42, 63488
    s_add_u32 s42, s42, 8192
    s_add_u32 s67, s62, 4
    s_and_b32 s67, s67, 3
    s_mul_i32 s43, s67, 12288
    s_add_u32 s83, s43, 63488
    s_add_u32 s43, s43, 0
    s_mov_b32 s76, 0x3e8b97f6
    s_mov_b32 s77, s76
    s_mov_b32 s78, -1
    s_mov_b32 s79, 0
    s_mul_i32 s75, s62, 12288
    s_add_u32 s75, s75, 53248
    v_and_b32 v250, 15, v0
    s_lshl_b32 s67, s62, 4
    v_add_u32 v250, s67, v250
    v_lshlrev_b32 v250, 7, v250
    v_bfe_u32 v16, v0, 4, 1
    v_lshl_add_u32 v250, v16, 13, v250
    v_add_u32 v250, 278528, v250
    v_writelane_b32 v250, s68, 32
    s_mov_b32 s44, -1
    s_mov_b32 s45, 1
    s_cmp_eq_u32 s63, 0
    s_cbranch_scc1 A_SPARE
    v_xor_b32 v6, 0x1000, v2
    v_xor_b32 v7, 0x1000, v3
    v_xor_b32 v8, 0x1000, v4
    v_xor_b32 v9, 0x1000, v5
    s_and_b32 s67, s62, 1
    s_lshl_b32 s67, s67, 1
    v_lshl_add_u32 v16, v12, 8, v15
    v_add_u32 v16, 16384, v16
    v_xor_b32 v17, s67, v14
    v_lshl_add_u32 v10, v17, 6, v16
    v_xor_b32 v17, 1, v17
    v_lshl_add_u32 v11, v17, 6, v16
    v_lshl_add_u32 v12, v12, 6, v15
    v_add_u32 v12, 49152, v12
    v_mov_b32 v13, 159744
    s_waitcnt lgkmcnt(0)
    s_barrier
    ds_read_b64_tr_b16 v[16:17], v12 offset:0
    ds_read_b64_tr_b16 v[18:19], v12 offset:256
    ds_read_b128 v[20:23], v2
    ds_read_b64_tr_b16 v[24:25], v10 offset:0
    ds_read_b64_tr_b16 v[26:27], v10 offset:1024
    ds_read_b64_tr_b16 v[28:29], v10 offset:16384
    ds_read_b64_tr_b16 v[30:31], v10 offset:17408
    ds_read_b128 v[32:35], v6
    ds_read_b64_tr_b16 v[36:37], v11 offset:0
    ds_read_b64_tr_b16 v[38:39], v11 offset:1024
    ds_read_b64_tr_b16 v[40:41], v11 offset:16384
    ds_read_b64_tr_b16 v[42:43], v11 offset:17408
    s_waitcnt lgkmcnt(9)
    v_mfma_f32_32x32x16_bf16 v[200:215], v[16:19], v[20:23], 0
    ds_read_b64_tr_b16 v[44:45], v12 offset:1024
    ds_read_b64_tr_b16 v[46:47], v12 offset:1280
    s_waitcnt lgkmcnt(9)
    v_mfma_f32_32x32x16_bf16 v[72:87], v[24:27], v[20:23], 0
    ds_read_b128 v[48:51], v3
    ds_read_b64_tr_b16 v[52:53], v10 offset:4096
    ds_read_b64_tr_b16 v[54:55], v10 offset:5120
    s_waitcnt lgkmcnt(10)
    v_mfma_f32_32x32x16_bf16 v[136:151], v[28:31], v[20:23], 0
    ds_read_b64_tr_b16 v[56:57], v10 offset:20480
    ds_read_b64_tr_b16 v[58:59], v10 offset:21504
    s_waitcnt lgkmcnt(11)
    v_mfma_f32_32x32x16_bf16 v[88:103], v[24:27], v[32:35], 0
    ds_read_b128 v[60:63], v7
    ds_read_b64_tr_b16 v[64:65], v11 offset:4096
    ds_read_b64_tr_b16 v[66:67], v11 offset:5120
    v_mfma_f32_32x32x16_bf16 v[152:167], v[28:31], v[32:35], 0
    ds_read_b64_tr_b16 v[68:69], v11 offset:20480
    s_waitcnt lgkmcnt(11)
    ds_read_b64_tr_b16 v[70:71], v11 offset:21504
    v_mfma_f32_32x32x16_bf16 v[104:119], v[36:39], v[20:23], 0
    v_mfma_f32_32x32x16_bf16 v[168:183], v[40:43], v[20:23], 0
    v_mfma_f32_32x32x16_bf16 v[120:135], v[36:39], v[32:35], 0
    v_mfma_f32_32x32x16_bf16 v[184:199], v[40:43], v[32:35], 0
    s_waitcnt lgkmcnt(2)
    v_mfma_f32_32x32x16_bf16 v[200:215], v[44:47], v[48:51], v[200:215]
    ds_read_b64_tr_b16 v[16:17], v12 offset:2048
    ds_read_b64_tr_b16 v[18:19], v12 offset:2304
    v_mfma_f32_32x32x16_bf16 v[72:87], v[52:55], v[48:51], v[72:87]
    ds_read_b128 v[24:27], v4
    ds_read_b64_tr_b16 v[28:29], v10 offset:8192
    ds_read_b64_tr_b16 v[30:31], v10 offset:9216
    v_mfma_f32_32x32x16_bf16 v[136:151], v[56:59], v[48:51], v[136:151]
    ds_read_b64_tr_b16 v[20:21], v10 offset:24576
    ds_read_b64_tr_b16 v[22:23], v10 offset:25600
    v_mfma_f32_32x32x16_bf16 v[88:103], v[52:55], v[60:63], v[88:103]
    ds_read_b128 v[36:39], v8
    ds_read_b64_tr_b16 v[40:41], v11 offset:8192
    ds_read_b64_tr_b16 v[42:43], v11 offset:9216
    v_mfma_f32_32x32x16_bf16 v[152:167], v[56:59], v[60:63], v[152:167]
    ds_read_b64_tr_b16 v[32:33], v11 offset:24576
    ds_read_b64_tr_b16 v[34:35], v11 offset:25600
    v_mfma_f32_32x32x16_bf16 v[104:119], v[64:67], v[48:51], v[104:119]
    s_waitcnt lgkmcnt(10)
    v_mfma_f32_32x32x16_bf16 v[168:183], v[68:71], v[48:51], v[168:183]
    v_mfma_f32_32x32x16_bf16 v[120:135], v[64:67], v[60:63], v[120:135]
    v_mfma_f32_32x32x16_bf16 v[184:199], v[68:71], v[60:63], v[184:199]
    s_waitcnt lgkmcnt(2)
    v_mfma_f32_32x32x16_bf16 v[200:215], v[16:19], v[24:27], v[200:215]
    ds_read_b64_tr_b16 v[44:45], v12 offset:3072
    ds_read_b64_tr_b16 v[46:47], v12 offset:3328
    v_mfma_f32_32x32x16_bf16 v[72:87], v[28:31], v[24:27], v[72:87]
    ds_read_b128 v[52:55], v5
    ds_read_b64_tr_b16 v[56:57], v10 offset:12288
    ds_read_b64_tr_b16 v[58:59], v10 offset:13312
    v_mfma_f32_32x32x16_bf16 v[136:151], v[20:23], v[24:27], v[136:151]
    ds_read_b64_tr_b16 v[48:49], v10 offset:28672
    ds_read_b64_tr_b16 v[50:51], v10 offset:29696
    v_mfma_f32_32x32x16_bf16 v[88:103], v[28:31], v[36:39], v[88:103]
    ds_read_b128 v[64:67], v9
    ds_read_b64_tr_b16 v[68:69], v11 offset:12288
    ds_read_b64_tr_b16 v[70:71], v11 offset:13312
    v_mfma_f32_32x32x16_bf16 v[152:167], v[20:23], v[36:39], v[152:167]
    ds_read_b64_tr_b16 v[60:61], v11 offset:28672
    ds_read_b64_tr_b16 v[62:63], v11 offset:29696
    v_mfma_f32_32x32x16_bf16 v[104:119], v[40:43], v[24:27], v[104:119]
    v_add_u32 v2, 53248, v2
    v_add_u32 v3, 53248, v3
    v_add_u32 v4, 53248, v4
    v_add_u32 v5, 53248, v5
    v_add_u32 v6, 53248, v6
    s_waitcnt lgkmcnt(10)
    v_mfma_f32_32x32x16_bf16 v[168:183], v[32:35], v[24:27], v[168:183]
    v_add_u32 v7, 53248, v7
    v_add_u32 v8, 53248, v8
    v_add_u32 v9, 53248, v9
    v_add_u32 v10, 53248, v10
    v_add_u32 v11, 53248, v11
    v_mfma_f32_32x32x16_bf16 v[120:135], v[40:43], v[36:39], v[120:135]
    v_add_u32 v12, 53248, v12
    v_mfma_f32_32x32x16_bf16 v[184:199], v[32:35], v[36:39], v[184:199]
    s_waitcnt lgkmcnt(2)
    v_mfma_f32_32x32x16_bf16 v[200:215], v[44:47], v[52:55], v[200:215]
    v_mfma_f32_32x32x16_bf16 v[72:87], v[56:59], v[52:55], v[72:87]
    s_waitcnt lgkmcnt(0)
    s_barrier
    ds_read_b64_tr_b16 v[16:17], v12 offset:0
    ds_read_b64_tr_b16 v[18:19], v12 offset:256
    v_mfma_f32_32x32x16_bf16 v[136:151], v[48:51], v[52:55], v[136:151]
    ds_read_b128 v[28:31], v2
    ds_read_b64_tr_b16 v[20:21], v10 offset:0
    ds_read_b64_tr_b16 v[22:23], v10 offset:1024
    v_mfma_f32_32x32x16_bf16 v[88:103], v[56:59], v[64:67], v[88:103]
    ds_read_b64_tr_b16 v[24:25], v10 offset:16384
    ds_read_b64_tr_b16 v[26:27], v10 offset:17408
    v_mfma_f32_32x32x16_bf16 v[152:167], v[48:51], v[64:67], v[152:167]
    ds_read_b128 v[40:43], v6
    ds_read_b64_tr_b16 v[32:33], v11 offset:0
    ds_read_b64_tr_b16 v[34:35], v11 offset:1024
    v_mfma_f32_32x32x16_bf16 v[104:119], v[68:71], v[52:55], v[104:119]
    ds_read_b64_tr_b16 v[36:37], v11 offset:16384
    ds_read_b64_tr_b16 v[38:39], v11 offset:17408
    v_mfma_f32_32x32x16_bf16 v[168:183], v[60:63], v[52:55], v[168:183]
    v_mfma_f32_32x32x16_bf16 v[120:135], v[68:71], v[64:67], v[120:135]
    v_mfma_f32_32x32x16_bf16 v[184:199], v[60:63], v[64:67], v[184:199]
    s_waitcnt lgkmcnt(5)
    v_mfma_f32_32x32x16_bf16 v[200:215], v[16:19], v[28:31], v[200:215]
    ds_read_b64_tr_b16 v[44:45], v12 offset:1024
    ds_read_b64_tr_b16 v[46:47], v12 offset:1280
    v_mfma_f32_32x32x16_bf16 v[72:87], v[20:23], v[28:31], v[72:87]
    ds_read_b128 v[56:59], v3
    ds_read_b64_tr_b16 v[48:49], v10 offset:4096
    ds_read_b64_tr_b16 v[50:51], v10 offset:5120
    v_mfma_f32_32x32x16_bf16 v[136:151], v[24:27], v[28:31], v[136:151]
    ds_read_b64_tr_b16 v[52:53], v10 offset:20480
    ds_read_b64_tr_b16 v[54:55], v10 offset:21504
    s_waitcnt lgkmcnt(7)
    v_mfma_f32_32x32x16_bf16 v[88:103], v[20:23], v[40:43], v[88:103]
    ds_read_b128 v[68:71], v7
    ds_read_b64_tr_b16 v[60:61], v11 offset:4096
    ds_read_b64_tr_b16 v[62:63], v11 offset:5120
    v_mfma_f32_32x32x16_bf16 v[152:167], v[24:27], v[40:43], v[152:167]
    ds_read_b64_tr_b16 v[64:65], v11 offset:20480
    ds_read_b64_tr_b16 v[66:67], v11 offset:21504
    v_mfma_f32_32x32x16_bf16 v[104:119], v[32:35], v[28:31], v[104:119]
    v_mfma_f32_32x32x16_bf16 v[168:183], v[36:39], v[28:31], v[168:183]
    v_mfma_f32_32x32x16_bf16 v[120:135], v[32:35], v[40:43], v[120:135]
    v_mfma_f32_32x32x16_bf16 v[184:199], v[36:39], v[40:43], v[184:199]
    s_waitcnt lgkmcnt(2)
    v_mfma_f32_32x32x16_bf16 v[200:215], v[44:47], v[56:59], v[200:215]
    ds_read_b64_tr_b16 v[16:17], v12 offset:2048
    ds_read_b64_tr_b16 v[18:19], v12 offset:2304
    v_mfma_f32_32x32x16_bf16 v[72:87], v[48:51], v[56:59], v[72:87]
    ds_read_b128 v[20:23], v4
    ds_read_b64_tr_b16 v[24:25], v10 offset:8192
    ds_read_b64_tr_b16 v[26:27], v10 offset:9216
    v_mfma_f32_32x32x16_bf16 v[136:151], v[52:55], v[56:59], v[136:151]
    ds_read_b64_tr_b16 v[28:29], v10 offset:24576
    ds_read_b64_tr_b16 v[30:31], v10 offset:25600
    v_mfma_f32_32x32x16_bf16 v[88:103], v[48:51], v[68:71], v[88:103]
    ds_read_b128 v[32:35], v8
    ds_read_b64_tr_b16 v[36:37], v11 offset:8192
    ds_read_b64_tr_b16 v[38:39], v11 offset:9216
    v_mfma_f32_32x32x16_bf16 v[152:167], v[52:55], v[68:71], v[152:167]
    ds_read_b64_tr_b16 v[40:41], v11 offset:24576
    ds_read_b64_tr_b16 v[42:43], v11 offset:25600
    v_mfma_f32_32x32x16_bf16 v[104:119], v[60:63], v[56:59], v[104:119]
    s_waitcnt lgkmcnt(10)
    v_mfma_f32_32x32x16_bf16 v[168:183], v[64:67], v[56:59], v[168:183]
    v_mfma_f32_32x32x16_bf16 v[120:135], v[60:63], v[68:71], v[120:135]
    v_mfma_f32_32x32x16_bf16 v[184:199], v[64:67], v[68:71], v[184:199]
    s_waitcnt lgkmcnt(2)
    v_mfma_f32_32x32x16_bf16 v[200:215], v[16:19], v[20:23], v[200:215]
    ds_read_b64_tr_b16 v[44:45], v12 offset:3072
    ds_read_b64_tr_b16 v[46:47], v12 offset:3328
    buffer_load_dword v249, v248, s[56:59], 0 offen sc1
    v_mfma_f32_32x32x16_bf16 v[72:87], v[24:27], v[20:23], v[72:87]
    ds_read_b128 v[48:51], v5
    ds_read_b64_tr_b16 v[52:53], v10 offset:12288
    ds_read_b64_tr_b16 v[54:55], v10 offset:13312
    v_mfma_f32_32x32x16_bf16 v[136:151], v[28:31], v[20:23], v[136:151]
    ds_read_b64_tr_b16 v[56:57], v10 offset:28672
    ds_read_b64_tr_b16 v[58:59], v10 offset:29696
    v_mfma_f32_32x32x16_bf16 v[88:103], v[24:27], v[32:35], v[88:103]
    ds_read_b128 v[60:63], v9
    ds_read_b64_tr_b16 v[64:65], v11 offset:12288
    ds_read_b64_tr_b16 v[66:67], v11 offset:13312
    v_mfma_f32_32x32x16_bf16 v[152:167], v[28:31], v[32:35], v[152:167]
    ds_read_b64_tr_b16 v[68:69], v11 offset:28672
    ds_read_b64_tr_b16 v[70:71], v11 offset:29696
    v_mfma_f32_32x32x16_bf16 v[104:119], v[36:39], v[20:23], v[104:119]
    v_add_u32 v2, 53248, v2
    v_add_u32 v3, 53248, v3
    v_add_u32 v4, 53248, v4
    v_add_u32 v5, 53248, v5
    v_add_u32 v6, 53248, v6
    s_waitcnt lgkmcnt(10)
    v_mfma_f32_32x32x16_bf16 v[168:183], v[40:43], v[20:23], v[168:183]
    v_add_u32 v7, 53248, v7
    v_add_u32 v8, 53248, v8
    v_add_u32 v9, 53248, v9
    v_add_u32 v10, 53248, v10
    v_add_u32 v11, 53248, v11
    v_mfma_f32_32x32x16_bf16 v[120:135], v[36:39], v[32:35], v[120:135]
    v_add_u32 v12, 53248, v12
    v_mfma_f32_32x32x16_bf16 v[184:199], v[40:43], v[32:35], v[184:199]
    s_waitcnt lgkmcnt(2)
    v_mfma_f32_32x32x16_bf16 v[200:215], v[44:47], v[48:51], v[200:215]
    v_mfma_f32_32x32x16_bf16 v[72:87], v[52:55], v[48:51], v[72:87]
    s_waitcnt lgkmcnt(0)
    s_barrier
    ds_read_b64_tr_b16 v[16:17], v12 offset:0
    ds_read_b64_tr_b16 v[18:19], v12 offset:256
    v_mfma_f32_32x32x16_bf16 v[136:151], v[56:59], v[48:51], v[136:151]
    ds_read_b128 v[24:27], v2
    ds_read_b64_tr_b16 v[28:29], v10 offset:0
    ds_read_b64_tr_b16 v[30:31], v10 offset:1024
    v_mfma_f32_32x32x16_bf16 v[88:103], v[52:55], v[60:63], v[88:103]
    ds_read_b64_tr_b16 v[20:21], v10 offset:16384
    ds_read_b64_tr_b16 v[22:23], v10 offset:17408
    v_mfma_f32_32x32x16_bf16 v[152:167], v[56:59], v[60:63], v[152:167]
    ds_read_b128 v[36:39], v6
    ds_read_b64_tr_b16 v[40:41], v11 offset:0
    ds_read_b64_tr_b16 v[42:43], v11 offset:1024
    v_mfma_f32_32x32x16_bf16 v[104:119], v[64:67], v[48:51], v[104:119]
    ds_read_b64_tr_b16 v[32:33], v11 offset:16384
    ds_read_b64_tr_b16 v[34:35], v11 offset:17408
    v_mfma_f32_32x32x16_bf16 v[168:183], v[68:71], v[48:51], v[168:183]
    v_mfma_f32_32x32x16_bf16 v[120:135], v[64:67], v[60:63], v[120:135]
    v_mfma_f32_32x32x16_bf16 v[184:199], v[68:71], v[60:63], v[184:199]
    s_waitcnt lgkmcnt(5)
    v_mfma_f32_32x32x16_bf16 v[200:215], v[16:19], v[24:27], v[200:215]
    ds_read_b64_tr_b16 v[44:45], v12 offset:1024
    ds_read_b64_tr_b16 v[46:47], v12 offset:1280
    v_mfma_f32_32x32x16_bf16 v[72:87], v[28:31], v[24:27], v[72:87]
    ds_read_b128 v[52:55], v3
    ds_read_b64_tr_b16 v[56:57], v10 offset:4096
    ds_read_b64_tr_b16 v[58:59], v10 offset:5120
    v_mfma_f32_32x32x16_bf16 v[136:151], v[20:23], v[24:27], v[136:151]
    ds_read_b64_tr_b16 v[48:49], v10 offset:20480
    ds_read_b64_tr_b16 v[50:51], v10 offset:21504
    s_waitcnt lgkmcnt(7)
    v_mfma_f32_32x32x16_bf16 v[88:103], v[28:31], v[36:39], v[88:103]
    ds_read_b128 v[64:67], v7
    ds_read_b64_tr_b16 v[68:69], v11 offset:4096
    ds_read_b64_tr_b16 v[70:71], v11 offset:5120
    v_mfma_f32_32x32x16_bf16 v[152:167], v[20:23], v[36:39], v[152:167]
    ds_read_b64_tr_b16 v[60:61], v11 offset:20480
    ds_read_b64_tr_b16 v[62:63], v11 offset:21504
    v_mfma_f32_32x32x16_bf16 v[104:119], v[40:43], v[24:27], v[104:119]
    v_mfma_f32_32x32x16_bf16 v[168:183], v[32:35], v[24:27], v[168:183]
    v_mfma_f32_32x32x16_bf16 v[120:135], v[40:43], v[36:39], v[120:135]
    v_mfma_f32_32x32x16_bf16 v[184:199], v[32:35], v[36:39], v[184:199]
    s_waitcnt lgkmcnt(2)
    v_mfma_f32_32x32x16_bf16 v[200:215], v[44:47], v[52:55], v[200:215]
    ds_read_b64_tr_b16 v[16:17], v12 offset:2048
    ds_read_b64_tr_b16 v[18:19], v12 offset:2304
    v_mfma_f32_32x32x16_bf16 v[72:87], v[56:59], v[52:55], v[72:87]
    ds_read_b128 v[28:31], v4
    ds_read_b64_tr_b16 v[20:21], v10 offset:8192
    ds_read_b64_tr_b16 v[22:23], v10 offset:9216
    v_mfma_f32_32x32x16_bf16 v[136:151], v[48:51], v[52:55], v[136:151]
    ds_read_b64_tr_b16 v[24:25], v10 offset:24576
    ds_read_b64_tr_b16 v[26:27], v10 offset:25600
    v_mfma_f32_32x32x16_bf16 v[88:103], v[56:59], v[64:67], v[88:103]
    ds_read_b128 v[40:43], v8
    ds_read_b64_tr_b16 v[32:33], v11 offset:8192
    ds_read_b64_tr_b16 v[34:35], v11 offset:9216
    v_mfma_f32_32x32x16_bf16 v[152:167], v[48:51], v[64:67], v[152:167]
    ds_read_b64_tr_b16 v[36:37], v11 offset:24576
    ds_read_b64_tr_b16 v[38:39], v11 offset:25600
    v_mfma_f32_32x32x16_bf16 v[104:119], v[68:71], v[52:55], v[104:119]
    s_waitcnt lgkmcnt(10)
    v_mfma_f32_32x32x16_bf16 v[168:183], v[60:63], v[52:55], v[168:183]
    v_mfma_f32_32x32x16_bf16 v[120:135], v[68:71], v[64:67], v[120:135]
    v_mfma_f32_32x32x16_bf16 v[184:199], v[60:63], v[64:67], v[184:199]
    s_waitcnt lgkmcnt(2)
    v_mfma_f32_32x32x16_bf16 v[200:215], v[16:19], v[28:31], v[200:215]
    ds_read_b64_tr_b16 v[44:45], v12 offset:3072
    ds_read_b64_tr_b16 v[46:47], v12 offset:3328
    v_mfma_f32_32x32x16_bf16 v[72:87], v[20:23], v[28:31], v[72:87]
    ds_read_b128 v[56:59], v5
    ds_read_b64_tr_b16 v[48:49], v10 offset:12288
    ds_read_b64_tr_b16 v[50:51], v10 offset:13312
    v_mfma_f32_32x32x16_bf16 v[136:151], v[24:27], v[28:31], v[136:151]
    ds_read_b64_tr_b16 v[52:53], v10 offset:28672
    ds_read_b64_tr_b16 v[54:55], v10 offset:29696
    v_mfma_f32_32x32x16_bf16 v[88:103], v[20:23], v[40:43], v[88:103]
    ds_read_b128 v[68:71], v9
    ds_read_b64_tr_b16 v[60:61], v11 offset:12288
    ds_read_b64_tr_b16 v[62:63], v11 offset:13312
    v_mfma_f32_32x32x16_bf16 v[152:167], v[24:27], v[40:43], v[152:167]
    ds_read_b64_tr_b16 v[64:65], v11 offset:28672
    ds_read_b64_tr_b16 v[66:67], v11 offset:29696
    v_mfma_f32_32x32x16_bf16 v[104:119], v[32:35], v[28:31], v[104:119]
    v_add_u32 v2, 4294860800, v2
    v_add_u32 v3, 4294860800, v3
    v_add_u32 v4, 4294860800, v4
    v_add_u32 v5, 4294860800, v5
    v_add_u32 v6, 4294860800, v6
    s_waitcnt lgkmcnt(10)
    v_mfma_f32_32x32x16_bf16 v[168:183], v[36:39], v[28:31], v[168:183]
    v_add_u32 v7, 4294860800, v7
    v_add_u32 v8, 4294860800, v8
    v_add_u32 v9, 4294860800, v9
    v_add_u32 v10, 4294860800, v10
    v_add_u32 v11, 4294860800, v11
    v_mfma_f32_32x32x16_bf16 v[120:135], v[32:35], v[40:43], v[120:135]
    v_add_u32 v12, 4294860800, v12
    v_mfma_f32_32x32x16_bf16 v[184:199], v[36:39], v[40:43], v[184:199]
    s_waitcnt lgkmcnt(2)
    v_mfma_f32_32x32x16_bf16 v[200:215], v[44:47], v[56:59], v[200:215]
    v_mfma_f32_32x32x16_bf16 v[72:87], v[48:51], v[56:59], v[72:87]
    s_waitcnt lgkmcnt(0)
    s_barrier
    ds_read_b64_tr_b16 v[16:17], v12 offset:0
    ds_read_b64_tr_b16 v[18:19], v12 offset:256
    v_mfma_f32_32x32x16_bf16 v[136:151], v[52:55], v[56:59], v[136:151]
    ds_read_b128 v[20:23], v2
    ds_read_b64_tr_b16 v[24:25], v10 offset:0
    ds_read_b64_tr_b16 v[26:27], v10 offset:1024
    v_mfma_f32_32x32x16_bf16 v[88:103], v[48:51], v[68:71], v[88:103]
    ds_read_b64_tr_b16 v[28:29], v10 offset:16384
    ds_read_b64_tr_b16 v[30:31], v10 offset:17408
    v_mfma_f32_32x32x16_bf16 v[152:167], v[52:55], v[68:71], v[152:167]
    ds_read_b128 v[32:35], v6
    ds_read_b64_tr_b16 v[36:37], v11 offset:0
    ds_read_b64_tr_b16 v[38:39], v11 offset:1024
    v_mfma_f32_32x32x16_bf16 v[104:119], v[60:63], v[56:59], v[104:119]
    ds_read_b64_tr_b16 v[40:41], v11 offset:16384
    ds_read_b64_tr_b16 v[42:43], v11 offset:17408
    v_mfma_f32_32x32x16_bf16 v[168:183], v[64:67], v[56:59], v[168:183]
    v_mfma_f32_32x32x16_bf16 v[120:135], v[60:63], v[68:71], v[120:135]
    v_mfma_f32_32x32x16_bf16 v[184:199], v[64:67], v[68:71], v[184:199]
    s_waitcnt lgkmcnt(5)
    v_mfma_f32_32x32x16_bf16 v[200:215], v[16:19], v[20:23], v[200:215]
    ds_read_b64_tr_b16 v[44:45], v12 offset:1024
    ds_read_b64_tr_b16 v[46:47], v12 offset:1280
    v_mfma_f32_32x32x16_bf16 v[72:87], v[24:27], v[20:23], v[72:87]
    ds_read_b128 v[48:51], v3
    ds_read_b64_tr_b16 v[52:53], v10 offset:4096
    ds_read_b64_tr_b16 v[54:55], v10 offset:5120
    v_mfma_f32_32x32x16_bf16 v[136:151], v[28:31], v[20:23], v[136:151]
    ds_read_b64_tr_b16 v[56:57], v10 offset:20480
    ds_read_b64_tr_b16 v[58:59], v10 offset:21504
    s_waitcnt lgkmcnt(7)
    v_mfma_f32_32x32x16_bf16 v[88:103], v[24:27], v[32:35], v[88:103]
    ds_read_b128 v[60:63], v7
    ds_read_b64_tr_b16 v[64:65], v11 offset:4096
    ds_read_b64_tr_b16 v[66:67], v11 offset:5120
    v_mfma_f32_32x32x16_bf16 v[152:167], v[28:31], v[32:35], v[152:167]
    ds_read_b64_tr_b16 v[68:69], v11 offset:20480
    ds_read_b64_tr_b16 v[70:71], v11 offset:21504
    v_mfma_f32_32x32x16_bf16 v[104:119], v[36:39], v[20:23], v[104:119]
    v_mfma_f32_32x32x16_bf16 v[168:183], v[40:43], v[20:23], v[168:183]
    v_mfma_f32_32x32x16_bf16 v[120:135], v[36:39], v[32:35], v[120:135]
    v_mfma_f32_32x32x16_bf16 v[184:199], v[40:43], v[32:35], v[184:199]
    s_waitcnt lgkmcnt(2)
    v_mfma_f32_32x32x16_bf16 v[200:215], v[44:47], v[48:51], v[200:215]
    ds_read_b64_tr_b16 v[16:17], v12 offset:2048
    ds_read_b64_tr_b16 v[18:19], v12 offset:2304
    v_mfma_f32_32x32x16_bf16 v[72:87], v[52:55], v[48:51], v[72:87]
    ds_read_b128 v[24:27], v4
    ds_read_b64_tr_b16 v[28:29], v10 offset:8192
    ds_read_b64_tr_b16 v[30:31], v10 offset:9216
    v_mfma_f32_32x32x16_bf16 v[136:151], v[56:59], v[48:51], v[136:151]
    ds_read_b64_tr_b16 v[20:21], v10 offset:24576
    ds_read_b64_tr_b16 v[22:23], v10 offset:25600
    v_mfma_f32_32x32x16_bf16 v[88:103], v[52:55], v[60:63], v[88:103]
    ds_read_b128 v[36:39], v8
    ds_read_b64_tr_b16 v[40:41], v11 offset:8192
    ds_read_b64_tr_b16 v[42:43], v11 offset:9216
    v_mfma_f32_32x32x16_bf16 v[152:167], v[56:59], v[60:63], v[152:167]
    ds_read_b64_tr_b16 v[32:33], v11 offset:24576
    ds_read_b64_tr_b16 v[34:35], v11 offset:25600
    v_mfma_f32_32x32x16_bf16 v[104:119], v[64:67], v[48:51], v[104:119]
    s_waitcnt vmcnt(0)
    v_readfirstlane_b32 s66, v249
    s_waitcnt lgkmcnt(10)
    v_mfma_f32_32x32x16_bf16 v[168:183], v[68:71], v[48:51], v[168:183]
    s_cmp_lg_u32 s66, 0
    s_cbranch_scc0 SL12
SL12B:
    ds_write_b32 v13, v249
    v_mfma_f32_32x32x16_bf16 v[120:135], v[64:67], v[60:63], v[120:135]
    v_mfma_f32_32x32x16_bf16 v[184:199], v[68:71], v[60:63], v[184:199]
    s_waitcnt lgkmcnt(3)
    v_mfma_f32_32x32x16_bf16 v[200:215], v[16:19], v[24:27], v[200:215]
    ds_read_b64_tr_b16 v[44:45], v12 offset:3072
    ds_read_b64_tr_b16 v[46:47], v12 offset:3328
    v_mfma_f32_32x32x16_bf16 v[72:87], v[28:31], v[24:27], v[72:87]
    ds_read_b128 v[52:55], v5
    ds_read_b64_tr_b16 v[56:57], v10 offset:12288
    ds_read_b64_tr_b16 v[58:59], v10 offset:13312
    v_mfma_f32_32x32x16_bf16 v[136:151], v[20:23], v[24:27], v[136:151]
    ds_read_b64_tr_b16 v[48:49], v10 offset:28672
    ds_read_b64_tr_b16 v[50:51], v10 offset:29696
    v_mfma_f32_32x32x16_bf16 v[88:103], v[28:31], v[36:39], v[88:103]
    ds_read_b128 v[64:67], v9
    ds_read_b64_tr_b16 v[68:69], v11 offset:12288
    ds_read_b64_tr_b16 v[70:71], v11 offset:13312
    v_mfma_f32_32x32x16_bf16 v[152:167], v[20:23], v[36:39], v[152:167]
    ds_read_b64_tr_b16 v[60:61], v11 offset:28672
    ds_read_b64_tr_b16 v[62:63], v11 offset:29696
    v_mfma_f32_32x32x16_bf16 v[104:119], v[40:43], v[24:27], v[104:119]
    v_add_u32 v2, 53248, v2
    v_add_u32 v3, 53248, v3
    v_add_u32 v4, 53248, v4
    v_add_u32 v5, 53248, v5
    v_add_u32 v6, 53248, v6
    s_waitcnt lgkmcnt(10)
    v_mfma_f32_32x32x16_bf16 v[168:183], v[32:35], v[24:27], v[168:183]
    v_add_u32 v7, 53248, v7
    v_add_u32 v8, 53248, v8
    v_add_u32 v9, 53248, v9
    v_add_u32 v10, 53248, v10
    v_add_u32 v11, 53248, v11
    v_mfma_f32_32x32x16_bf16 v[120:135], v[40:43], v[36:39], v[120:135]
    v_add_u32 v12, 53248, v12
    v_mfma_f32_32x32x16_bf16 v[184:199], v[32:35], v[36:39], v[184:199]
    s_waitcnt lgkmcnt(2)
    v_mfma_f32_32x32x16_bf16 v[200:215], v[44:47], v[52:55], v[200:215]
    v_mfma_f32_32x32x16_bf16 v[72:87], v[56:59], v[52:55], v[72:87]
    s_waitcnt lgkmcnt(0)
    s_barrier
    ds_read_b64_tr_b16 v[16:17], v12 offset:0
    ds_read_b64_tr_b16 v[18:19], v12 offset:256
    v_mfma_f32_32x32x16_bf16 v[136:151], v[48:51], v[52:55], v[136:151]
    ds_read_b128 v[28:31], v2
    ds_read_b64_tr_b16 v[20:21], v10 offset:0
    ds_read_b64_tr_b16 v[22:23], v10 offset:1024
    v_mfma_f32_32x32x16_bf16 v[88:103], v[56:59], v[64:67], v[88:103]
    ds_read_b64_tr_b16 v[24:25], v10 offset:16384
    ds_read_b64_tr_b16 v[26:27], v10 offset:17408
    v_mfma_f32_32x32x16_bf16 v[152:167], v[48:51], v[64:67], v[152:167]
    ds_read_b128 v[40:43], v6
    ds_read_b64_tr_b16 v[32:33], v11 offset:0
    ds_read_b64_tr_b16 v[34:35], v11 offset:1024
    v_mfma_f32_32x32x16_bf16 v[104:119], v[68:71], v[52:55], v[104:119]
    ds_read_b64_tr_b16 v[36:37], v11 offset:16384
    ds_read_b64_tr_b16 v[38:39], v11 offset:17408
    v_mfma_f32_32x32x16_bf16 v[168:183], v[60:63], v[52:55], v[168:183]
    v_mfma_f32_32x32x16_bf16 v[120:135], v[68:71], v[64:67], v[120:135]
    v_mfma_f32_32x32x16_bf16 v[184:199], v[60:63], v[64:67], v[184:199]
    s_waitcnt lgkmcnt(5)
    v_mfma_f32_32x32x16_bf16 v[200:215], v[16:19], v[28:31], v[200:215]
    ds_read_b64_tr_b16 v[44:45], v12 offset:1024
    ds_read_b64_tr_b16 v[46:47], v12 offset:1280
    v_mfma_f32_32x32x16_bf16 v[72:87], v[20:23], v[28:31], v[72:87]
    ds_read_b128 v[56:59], v3
    ds_read_b64_tr_b16 v[48:49], v10 offset:4096
    ds_read_b64_tr_b16 v[50:51], v10 offset:5120
    v_mfma_f32_32x32x16_bf16 v[136:151], v[24:27], v[28:31], v[136:151]
    ds_read_b64_tr_b16 v[52:53], v10 offset:20480
    ds_read_b64_tr_b16 v[54:55], v10 offset:21504
    s_waitcnt lgkmcnt(7)
    v_mfma_f32_32x32x16_bf16 v[88:103], v[20:23], v[40:43], v[88:103]
    ds_read_b128 v[68:71], v7
    ds_read_b64_tr_b16 v[60:61], v11 offset:4096
    ds_read_b64_tr_b16 v[62:63], v11 offset:5120
    v_mfma_f32_32x32x16_bf16 v[152:167], v[24:27], v[40:43], v[152:167]
    ds_read_b64_tr_b16 v[64:65], v11 offset:20480
    ds_read_b64_tr_b16 v[66:67], v11 offset:21504
    v_mfma_f32_32x32x16_bf16 v[104:119], v[32:35], v[28:31], v[104:119]
    v_mfma_f32_32x32x16_bf16 v[168:183], v[36:39], v[28:31], v[168:183]
    v_mfma_f32_32x32x16_bf16 v[120:135], v[32:35], v[40:43], v[120:135]
    v_mfma_f32_32x32x16_bf16 v[184:199], v[36:39], v[40:43], v[184:199]
    s_waitcnt lgkmcnt(2)
    v_mfma_f32_32x32x16_bf16 v[200:215], v[44:47], v[56:59], v[200:215]
    ds_read_b64_tr_b16 v[16:17], v12 offset:2048
    ds_read_b64_tr_b16 v[18:19], v12 offset:2304
    v_mfma_f32_32x32x16_bf16 v[72:87], v[48:51], v[56:59], v[72:87]
    ds_read_b128 v[20:23], v4
    ds_read_b64_tr_b16 v[24:25], v10 offset:8192
    ds_read_b64_tr_b16 v[26:27], v10 offset:9216
    v_mfma_f32_32x32x16_bf16 v[136:151], v[52:55], v[56:59], v[136:151]
    ds_read_b64_tr_b16 v[28:29], v10 offset:24576
    ds_read_b64_tr_b16 v[30:31], v10 offset:25600
    v_mfma_f32_32x32x16_bf16 v[88:103], v[48:51], v[68:71], v[88:103]
    ds_read_b128 v[32:35], v8
    ds_read_b64_tr_b16 v[36:37], v11 offset:8192
    ds_read_b64_tr_b16 v[38:39], v11 offset:9216
    v_mfma_f32_32x32x16_bf16 v[152:167], v[52:55], v[68:71], v[152:167]
    ds_read_b64_tr_b16 v[40:41], v11 offset:24576
    ds_read_b64_tr_b16 v[42:43], v11 offset:25600
    v_mfma_f32_32x32x16_bf16 v[104:119], v[60:63], v[56:59], v[104:119]
    s_waitcnt lgkmcnt(10)
    v_mfma_f32_32x32x16_bf16 v[168:183], v[64:67], v[56:59], v[168:183]
    v_mfma_f32_32x32x16_bf16 v[120:135], v[60:63], v[68:71], v[120:135]
    v_mfma_f32_32x32x16_bf16 v[184:199], v[64:67], v[68:71], v[184:199]
    s_waitcnt lgkmcnt(2)
    v_mfma_f32_32x32x16_bf16 v[200:215], v[16:19], v[20:23], v[200:215]
    ds_read_b64_tr_b16 v[44:45], v12 offset:3072
    ds_read_b64_tr_b16 v[46:47], v12 offset:3328
    v_mfma_f32_32x32x16_bf16 v[72:87], v[24:27], v[20:23], v[72:87]
    ds_read_b128 v[48:51], v5
    ds_read_b64_tr_b16 v[52:53], v10 offset:12288
    ds_read_b64_tr_b16 v[54:55], v10 offset:13312
    v_mfma_f32_32x32x16_bf16 v[136:151], v[28:31], v[20:23], v[136:151]
    ds_read_b64_tr_b16 v[56:57], v10 offset:28672
    ds_read_b64_tr_b16 v[58:59], v10 offset:29696
    v_mfma_f32_32x32x16_bf16 v[88:103], v[24:27], v[32:35], v[88:103]
    ds_read_b128 v[60:63], v9
    ds_read_b64_tr_b16 v[64:65], v11 offset:12288
    ds_read_b64_tr_b16 v[66:67], v11 offset:13312
    v_mfma_f32_32x32x16_bf16 v[152:167], v[28:31], v[32:35], v[152:167]
    ds_read_b64_tr_b16 v[68:69], v11 offset:28672
    ds_read_b64_tr_b16 v[70:71], v11 offset:29696
    v_mfma_f32_32x32x16_bf16 v[104:119], v[36:39], v[20:23], v[104:119]
    v_add_u32 v2, 53248, v2
    v_add_u32 v3, 53248, v3
    v_add_u32 v4, 53248, v4
    v_add_u32 v5, 53248, v5
    v_add_u32 v6, 53248, v6
    s_waitcnt lgkmcnt(10)
    v_mfma_f32_32x32x16_bf16 v[168:183], v[40:43], v[20:23], v[168:183]
    v_add_u32 v7, 53248, v7
    v_add_u32 v8, 53248, v8
    v_add_u32 v9, 53248, v9
    v_add_u32 v10, 53248, v10
    v_add_u32 v11, 53248, v11
    v_mfma_f32_32x32x16_bf16 v[120:135], v[36:39], v[32:35], v[120:135]
    v_add_u32 v12, 53248, v12
    v_mfma_f32_32x32x16_bf16 v[184:199], v[40:43], v[32:35], v[184:199]
    s_waitcnt lgkmcnt(2)
    v_mfma_f32_32x32x16_bf16 v[200:215], v[44:47], v[48:51], v[200:215]
    s_mov_b64 exec, s[44:45]
    buffer_load_dword v252, v250, s[48:51], 0 offen sc1
    s_mov_b64 exec, -1
    v_mfma_f32_32x32x16_bf16 v[72:87], v[52:55], v[48:51], v[72:87]
    s_waitcnt lgkmcnt(0)
    s_barrier
    ds_read_b64_tr_b16 v[16:17], v12 offset:0
    ds_read_b64_tr_b16 v[18:19], v12 offset:256
    v_mfma_f32_32x32x16_bf16 v[136:151], v[56:59], v[48:51], v[136:151]
    ds_read_b128 v[24:27], v2
    ds_read_b64_tr_b16 v[28:29], v10 offset:0
    ds_read_b64_tr_b16 v[30:31], v10 offset:1024
    v_mfma_f32_32x32x16_bf16 v[88:103], v[52:55], v[60:63], v[88:103]
    ds_read_b64_tr_b16 v[20:21], v10 offset:16384
    ds_read_b64_tr_b16 v[22:23], v10 offset:17408
    v_mfma_f32_32x32x16_bf16 v[152:167], v[56:59], v[60:63], v[152:167]
    ds_read_b128 v[36:39], v6
    ds_read_b64_tr_b16 v[40:41], v12 offset:1024
    ds_read_b64_tr_b16 v[42:43], v12 offset:1280
    v_mfma_f32_32x32x16_bf16 v[104:119], v[64:67], v[48:51], v[104:119]
    ds_read_b128 v[32:35], v3
    ds_read_b64_tr_b16 v[44:45], v10 offset:4096
    ds_read_b64_tr_b16 v[46:47], v10 offset:5120
    v_mfma_f32_32x32x16_bf16 v[168:183], v[68:71], v[48:51], v[168:183]
    ds_read_b64_tr_b16 v[52:53], v10 offset:20480
    ds_read_b64_tr_b16 v[54:55], v10 offset:21504
    v_mfma_f32_32x32x16_bf16 v[120:135], v[64:67], v[60:63], v[120:135]
    s_waitcnt lgkmcnt(10)
    ds_read_b128 v[56:59], v7
    v_mfma_f32_32x32x16_bf16 v[184:199], v[68:71], v[60:63], v[184:199]
    v_mfma_f32_32x32x16_bf16 v[200:215], v[16:19], v[24:27], v[200:215]
    ds_read_b64_tr_b16 v[48:49], v12 offset:2048
    ds_read_b64_tr_b16 v[50:51], v12 offset:2304
    ds_read_b128 v[64:67], v4
    v_mfma_f32_32x32x16_bf16 v[72:87], v[28:31], v[24:27], v[72:87]
    ds_read_b64_tr_b16 v[68:69], v10 offset:8192
    s_waitcnt lgkmcnt(7)
    ds_read_b64_tr_b16 v[70:71], v10 offset:9216
    ds_read_b64_tr_b16 v[60:61], v10 offset:24576
    ds_read_b64_tr_b16 v[62:63], v10 offset:25600
    v_mfma_f32_32x32x16_bf16 v[136:151], v[20:23], v[24:27], v[136:151]
    ds_read_b128 v[16:19], v8
    v_mfma_f32_32x32x16_bf16 v[88:103], v[28:31], v[36:39], v[88:103]
    v_mfma_f32_32x32x16_bf16 v[152:167], v[20:23], v[36:39], v[152:167]
    v_mfma_f32_32x32x16_bf16 v[200:215], v[40:43], v[32:35], v[200:215]
    ds_read_b64_tr_b16 v[24:25], v12 offset:3072
    ds_read_b64_tr_b16 v[26:27], v12 offset:3328
    ds_read_b128 v[28:31], v5
    v_mfma_f32_32x32x16_bf16 v[72:87], v[44:47], v[32:35], v[72:87]
    ds_read_b64_tr_b16 v[20:21], v10 offset:12288
    s_waitcnt lgkmcnt(5)
    ds_read_b64_tr_b16 v[22:23], v10 offset:13312
    ds_read_b64_tr_b16 v[36:37], v10 offset:28672
    ds_read_b64_tr_b16 v[38:39], v10 offset:29696
    v_mfma_f32_32x32x16_bf16 v[136:151], v[52:55], v[32:35], v[136:151]
    ds_read_b128 v[40:43], v9
    v_mfma_f32_32x32x16_bf16 v[88:103], v[44:47], v[56:59], v[88:103]
    v_mfma_f32_32x32x16_bf16 v[152:167], v[52:55], v[56:59], v[152:167]
    v_mfma_f32_32x32x16_bf16 v[200:215], v[48:51], v[64:67], v[200:215]
    ds_read_b64_tr_b16 v[32:33], v11 offset:0
    ds_read_b64_tr_b16 v[34:35], v11 offset:1024
    ds_read_b128 v[44:47], v2
    v_mfma_f32_32x32x16_bf16 v[72:87], v[68:71], v[64:67], v[72:87]
    ds_read_b64_tr_b16 v[52:53], v11 offset:16384
    ds_read_b64_tr_b16 v[54:55], v11 offset:17408
    ds_read_b128 v[56:59], v6
    v_mfma_f32_32x32x16_bf16 v[136:151], v[60:63], v[64:67], v[136:151]
    s_waitcnt lgkmcnt(6)
    v_mfma_f32_32x32x16_bf16 v[88:103], v[68:71], v[16:19], v[88:103]
    v_mfma_f32_32x32x16_bf16 v[152:167], v[60:63], v[16:19], v[152:167]
    v_mfma_f32_32x32x16_bf16 v[200:215], v[24:27], v[28:31], v[200:215]
    s_waitcnt vmcnt(0)
    v_cmp_eq_u32 vcc, s66, v252
    ds_read_b64_tr_b16 v[48:49], v11 offset:4096
    ds_read_b64_tr_b16 v[50:51], v11 offset:5120
    ds_read_b128 v[64:67], v3
    v_mfma_f32_32x32x16_bf16 v[72:87], v[20:23], v[28:31], v[72:87]
    s_and_b64 vcc, vcc, s[44:45]
    s_cmp_eq_u64 vcc, s[44:45]
    s_cselect_b32 s54, 65536, 0
    s_cselect_b32 s46, s69, 16777216
    ds_read_b64_tr_b16 v[68:69], v11 offset:20480
    ds_read_b64_tr_b16 v[70:71], v11 offset:21504
    ds_read_b128 v[60:63], v7
    buffer_load_dwordx4 v[216:219], v1, s[52:55], 0 offen offset:0 sc1
    v_mfma_f32_32x32x16_bf16 v[136:151], v[36:39], v[28:31], v[136:151]
    v_add_u32 v2, 4294860800, v2
    v_add_u32 v3, 4294860800, v3
    v_add_u32 v4, 4294860800, v4
    v_add_u32 v5, 4294860800, v5
    v_add_u32 v6, 4294860800, v6
    v_mfma_f32_32x32x16_bf16 v[88:103], v[20:23], v[40:43], v[88:103]
    v_add_u32 v7, 4294860800, v7
    v_add_u32 v8, 4294860800, v8
    v_add_u32 v9, 4294860800, v9
    v_add_u32 v10, 4294860800, v10
    v_add_u32 v11, 4294860800, v11
    v_mfma_f32_32x32x16_bf16 v[152:167], v[36:39], v[40:43], v[152:167]
    v_add_u32 v12, 4294860800, v12
    buffer_load_dwordx4 v[220:223], v1, s[52:55], 0 offen offset:1024 sc1
    buffer_load_dwordx4 v[224:227], v1, s[52:55], 0 offen offset:2048 sc1
    s_waitcnt lgkmcnt(6)
    v_mfma_f32_32x32x16_bf16 v[104:119], v[32:35], v[44:47], v[104:119]
    s_waitcnt lgkmcnt(0)
    s_barrier
    ds_read_b64_tr_b16 v[16:17], v12 offset:0
    ds_read_b64_tr_b16 v[18:19], v12 offset:256
    ds_read_b128 v[24:27], v2
    buffer_load_dwordx4 v[228:231], v1, s[52:55], 0 offen offset:3072 sc1
    v_mfma_f32_32x32x16_bf16 v[168:183], v[52:55], v[44:47], v[168:183]
    ds_read_b64_tr_b16 v[28:29], v10 offset:0
    ds_read_b64_tr_b16 v[30:31], v10 offset:1024
    ds_read_b64_tr_b16 v[20:21], v10 offset:16384
    ds_read_b64_tr_b16 v[22:23], v10 offset:17408
    buffer_load_dwordx4 v[232:235], v1, s[52:55], s73 offen offset:0 sc1
    v_mfma_f32_32x32x16_bf16 v[120:135], v[32:35], v[56:59], v[120:135]
    ds_read_b128 v[36:39], v6
    buffer_load_dwordx4 v[236:239], v1, s[52:55], s73 offen offset:1024 sc1
    buffer_load_dwordx4 v[240:243], v1, s[52:55], s73 offen offset:2048 sc1
    v_mfma_f32_32x32x16_bf16 v[184:199], v[52:55], v[56:59], v[184:199]
    buffer_load_dwordx4 v[244:247], v1, s[52:55], s73 offen offset:3072 sc1
    v_and_b32 v15, 31, v0
    v_lshlrev_b32 v15, 2, v15
    buffer_load_dword v14, v15, s[48:51], s46 offen sc1
    s_movk_i32 s73, 8192
    v_mfma_f32_32x32x16_bf16 v[104:119], v[48:51], v[64:67], v[104:119]
    ds_read_b64_tr_b16 v[40:41], v12 offset:1024
    ds_read_b64_tr_b16 v[42:43], v12 offset:1280
    ds_read_b128 v[44:47], v3
    s_lshl_b32 s67, s62, 2
    v_add_u32 v15, s67, v13
    ds_write_b32 v15, v13 offset:48
    v_mfma_f32_32x32x16_bf16 v[168:183], v[68:71], v[64:67], v[168:183]
    ds_read_b64_tr_b16 v[32:33], v10 offset:4096
    ds_read_b64_tr_b16 v[34:35], v10 offset:5120
    ds_read_b64_tr_b16 v[52:53], v10 offset:20480
    s_waitcnt lgkmcnt(12)
    ds_read_b64_tr_b16 v[54:55], v10 offset:21504
    v_mfma_f32_32x32x16_bf16 v[120:135], v[48:51], v[60:63], v[120:135]
    ds_read_b128 v[56:59], v7
    v_mfma_f32_32x32x16_bf16 v[184:199], v[68:71], v[60:63], v[184:199]
    v_mfma_f32_32x32x16_bf16 v[200:215], v[16:19], v[24:27], v[200:215]
    ds_read_b64_tr_b16 v[64:65], v12 offset:2048
    s_waitcnt lgkmcnt(10)
    ds_read_b64_tr_b16 v[66:67], v12 offset:2304
    ds_read_b128 v[48:51], v4
    v_mfma_f32_32x32x16_bf16 v[72:87], v[28:31], v[24:27], v[72:87]
    ds_read_b64_tr_b16 v[68:69], v10 offset:8192
    ds_read_b64_tr_b16 v[70:71], v10 offset:9216
    ds_read_b64_tr_b16 v[60:61], v10 offset:24576
    s_waitcnt lgkmcnt(11)
    ds_read_b64_tr_b16 v[62:63], v10 offset:25600
    v_mfma_f32_32x32x16_bf16 v[136:151], v[20:23], v[24:27], v[136:151]
    ds_read_b128 v[16:19], v8
    v_mfma_f32_32x32x16_bf16 v[88:103], v[28:31], v[36:39], v[88:103]
    v_mfma_f32_32x32x16_bf16 v[152:167], v[20:23], v[36:39], v[152:167]
    v_mfma_f32_32x32x16_bf16 v[200:215], v[40:43], v[44:47], v[200:215]
    ds_read_b64_tr_b16 v[24:25], v12 offset:3072
    ds_read_b64_tr_b16 v[26:27], v12 offset:3328
    s_waitcnt lgkmcnt(7)
    ds_read_b128 v[28:31], v5
    v_mfma_f32_32x32x16_bf16 v[72:87], v[32:35], v[44:47], v[72:87]
    ds_read_b64_tr_b16 v[20:21], v10 offset:12288
    ds_read_b64_tr_b16 v[22:23], v10 offset:13312
    ds_read_b64_tr_b16 v[36:37], v10 offset:28672
    ds_read_b64_tr_b16 v[38:39], v10 offset:29696
    v_mfma_f32_32x32x16_bf16 v[136:151], v[52:55], v[44:47], v[136:151]
    ds_read_b128 v[40:43], v9
    v_add_u32 v2, 106496, v2
    v_add_u32 v3, 106496, v3
    v_add_u32 v4, 106496, v4
    v_add_u32 v5, 106496, v5
    v_mfma_f32_32x32x16_bf16 v[88:103], v[32:35], v[56:59], v[88:103]
    v_add_u32 v6, 106496, v6
    v_add_u32 v7, 106496, v7
    v_add_u32 v8, 106496, v8
    v_add_u32 v9, 106496, v9
    v_add_u32 v10, 106496, v10
    v_mfma_f32_32x32x16_bf16 v[152:167], v[52:55], v[56:59], v[152:167]
    v_add_u32 v11, 106496, v11
    v_add_u32 v12, 106496, v12
    v_mfma_f32_32x32x16_bf16 v[200:215], v[64:67], v[48:51], v[200:215]
    ds_read_b64_tr_b16 v[44:45], v11 offset:8192
    ds_read_b64_tr_b16 v[46:47], v11 offset:9216
    s_waitcnt lgkmcnt(7)
    ds_read_b128 v[32:35], v4
    v_mfma_f32_32x32x16_bf16 v[72:87], v[68:71], v[48:51], v[72:87]
    ds_read_b64_tr_b16 v[52:53], v11 offset:24576
    ds_read_b64_tr_b16 v[54:55], v11 offset:25600
    ds_read_b128 v[56:59], v8
    v_mfma_f32_32x32x16_bf16 v[136:151], v[60:63], v[48:51], v[136:151]
    v_mfma_f32_32x32x16_bf16 v[88:103], v[68:71], v[16:19], v[88:103]
    v_mfma_f32_32x32x16_bf16 v[152:167], v[60:63], v[16:19], v[152:167]
    v_mfma_f32_32x32x16_bf16 v[200:215], v[24:27], v[28:31], v[200:215]
    ds_read_b64_tr_b16 v[64:65], v11 offset:12288
    ds_read_b64_tr_b16 v[66:67], v11 offset:13312
    ds_read_b128 v[48:51], v5
    s_waitcnt lgkmcnt(6)
    v_mfma_f32_32x32x16_bf16 v[72:87], v[20:23], v[28:31], v[72:87]
    ds_read_b64_tr_b16 v[68:69], v11 offset:28672
    ds_read_b64_tr_b16 v[70:71], v11 offset:29696
    ds_read_b128 v[60:63], v9
    v_mfma_f32_32x32x16_bf16 v[136:151], v[36:39], v[28:31], v[136:151]
    v_add_u32 v2, 4294860800, v2
    v_add_u32 v3, 4294860800, v3
    v_add_u32 v4, 4294860800, v4
    v_add_u32 v5, 4294860800, v5
    v_add_u32 v6, 4294860800, v6
    v_mfma_f32_32x32x16_bf16 v[88:103], v[20:23], v[40:43], v[88:103]
    v_add_u32 v7, 4294860800, v7
    v_add_u32 v8, 4294860800, v8
    v_add_u32 v9, 4294860800, v9
    v_add_u32 v10, 4294860800, v10
    v_add_u32 v11, 4294860800, v11
    v_mfma_f32_32x32x16_bf16 v[152:167], v[36:39], v[40:43], v[152:167]
    v_add_u32 v12, 4294860800, v12
    v_mfma_f32_32x32x16_bf16 v[104:119], v[44:47], v[32:35], v[104:119]
    ds_read_b64_tr_b16 v[16:17], v11 offset:0
    ds_read_b64_tr_b16 v[18:19], v11 offset:1024
    ds_read_b128 v[24:27], v2
    s_waitcnt lgkmcnt(6)
    v_mfma_f32_32x32x16_bf16 v[168:183], v[52:55], v[32:35], v[168:183]
    ds_read_b64_tr_b16 v[28:29], v11 offset:16384
    ds_read_b64_tr_b16 v[30:31], v11 offset:17408
    ds_read_b128 v[20:23], v6
    v_add_u32 v251, s75, v1
    v_mov_b32 v249, 1
    v_mfma_f32_32x32x16_bf16 v[120:135], v[44:47], v[56:59], v[120:135]
    s_lshl_b32 s67, s62, 2
    v_add_u32 v15, s67, v13
    v_pk_mul_f32 v[72:73], v[72:73], v[136:137]
    v_pk_mul_f32 v[74:75], v[74:75], v[138:139]
    v_pk_mul_f32 v[76:77], v[76:77], v[140:141]
    v_mfma_f32_32x32x16_bf16 v[184:199], v[52:55], v[56:59], v[184:199]
    v_pk_mul_f32 v[78:79], v[78:79], v[142:143]
    v_pk_mul_f32 v[80:81], v[80:81], v[144:145]
    v_pk_mul_f32 v[82:83], v[82:83], v[146:147]
    v_pk_mul_f32 v[84:85], v[84:85], v[148:149]
    v_pk_mul_f32 v[86:87], v[86:87], v[150:151]
    v_mfma_f32_32x32x16_bf16 v[104:119], v[64:67], v[48:51], v[104:119]
    ds_read_b64_tr_b16 v[36:37], v11 offset:4096
    ds_read_b64_tr_b16 v[38:39], v11 offset:5120
    ds_read_b128 v[40:43], v3
    v_cvt_pk_bf16_f32 v136, v72, v73
    v_cvt_pk_bf16_f32 v137, v74, v75
    s_waitcnt lgkmcnt(9)
    v_mfma_f32_32x32x16_bf16 v[168:183], v[68:71], v[48:51], v[168:183]
    ds_read_b64_tr_b16 v[32:33], v11 offset:20480
    ds_read_b64_tr_b16 v[34:35], v11 offset:21504
    ds_read_b128 v[44:47], v7
    v_cvt_pk_bf16_f32 v138, v76, v77
    v_cvt_pk_bf16_f32 v139, v78, v79
    v_mfma_f32_32x32x16_bf16 v[120:135], v[64:67], v[60:63], v[120:135]
    ds_write_b128 v251, v[136:139] offset:0
    v_cvt_pk_bf16_f32 v140, v80, v81
    v_cvt_pk_bf16_f32 v141, v82, v83
    v_cvt_pk_bf16_f32 v142, v84, v85
    v_mfma_f32_32x32x16_bf16 v[184:199], v[68:71], v[60:63], v[184:199]
    v_cvt_pk_bf16_f32 v143, v86, v87
    ds_write_b128 v251, v[140:143] offset:1024
    v_pk_mul_f32 v[88:89], v[88:89], v[152:153]
    v_pk_mul_f32 v[90:91], v[90:91], v[154:155]
    s_waitcnt lgkmcnt(8)
    v_mfma_f32_32x32x16_bf16 v[104:119], v[16:19], v[24:27], v[104:119]
    ds_read_b64_tr_b16 v[52:53], v11 offset:8192
    ds_read_b64_tr_b16 v[54:55], v11 offset:9216
    ds_read_b128 v[56:59], v4
    v_pk_mul_f32 v[92:93], v[92:93], v[156:157]
    v_pk_mul_f32 v[94:95], v[94:95], v[158:159]
    v_mfma_f32_32x32x16_bf16 v[168:183], v[28:31], v[24:27], v[168:183]
    ds_read_b64_tr_b16 v[48:49], v11 offset:24576
    ds_read_b64_tr_b16 v[50:51], v11 offset:25600
    ds_read_b128 v[64:67], v8
    v_pk_mul_f32 v[96:97], v[96:97], v[160:161]
    v_pk_mul_f32 v[98:99], v[98:99], v[162:163]
    v_mfma_f32_32x32x16_bf16 v[120:135], v[16:19], v[20:23], v[120:135]
    v_pk_mul_f32 v[100:101], v[100:101], v[164:165]
    v_pk_mul_f32 v[102:103], v[102:103], v[166:167]
    v_cvt_pk_bf16_f32 v152, v88, v89
    v_cvt_pk_bf16_f32 v153, v90, v91
    v_cvt_pk_bf16_f32 v154, v92, v93
    v_mfma_f32_32x32x16_bf16 v[184:199], v[28:31], v[20:23], v[184:199]
    v_cvt_pk_bf16_f32 v155, v94, v95
    ds_write_b128 v251, v[152:155] offset:2048
    v_cvt_pk_bf16_f32 v156, v96, v97
    v_cvt_pk_bf16_f32 v157, v98, v99
    s_waitcnt lgkmcnt(8)
    v_mfma_f32_32x32x16_bf16 v[104:119], v[36:39], v[40:43], v[104:119]
    ds_read_b64_tr_b16 v[68:69], v11 offset:12288
    ds_read_b64_tr_b16 v[70:71], v11 offset:13312
    ds_read_b128 v[60:63], v5
    v_cvt_pk_bf16_f32 v158, v100, v101
    v_cvt_pk_bf16_f32 v159, v102, v103
    v_mfma_f32_32x32x16_bf16 v[168:183], v[32:35], v[40:43], v[168:183]
    ds_read_b64_tr_b16 v[24:25], v11 offset:28672
    ds_read_b64_tr_b16 v[26:27], v11 offset:29696
    ds_read_b128 v[16:19], v9
    ds_write_b128 v251, v[156:159] offset:3072
    v_mfma_f32_32x32x16_bf16 v[120:135], v[36:39], v[44:47], v[120:135]
    s_waitcnt lgkmcnt(8)
    ds_write_b32 v15, v249 offset:16
    v_pk_mul_f32 v[200:201], v[200:201], s[76:77]
    v_pk_mul_f32 v[202:203], v[202:203], s[76:77]
    v_pk_mul_f32 v[204:205], v[204:205], s[76:77]
    v_mfma_f32_32x32x16_bf16 v[184:199], v[32:35], v[44:47], v[184:199]
    v_pk_mul_f32 v[206:207], v[206:207], s[76:77]
    v_pk_mul_f32 v[208:209], v[208:209], s[76:77]
    v_pk_mul_f32 v[210:211], v[210:211], s[76:77]
    v_pk_mul_f32 v[212:213], v[212:213], s[76:77]
    v_pk_mul_f32 v[214:215], v[214:215], s[76:77]
    v_mfma_f32_32x32x16_bf16 v[104:119], v[52:55], v[56:59], v[104:119]
    v_cvt_pk_bf16_f32 v144, v200, v201
    v_cvt_pk_bf16_f32 v145, v202, v203
    v_cvt_pk_bf16_f32 v146, v204, v205
    v_cvt_pk_bf16_f32 v147, v206, v207
    v_cvt_pk_bf16_f32 v148, v208, v209
    v_mfma_f32_32x32x16_bf16 v[168:183], v[48:51], v[56:59], v[168:183]
    v_cvt_pk_bf16_f32 v149, v210, v211
    v_cvt_pk_bf16_f32 v150, v212, v213
    v_cvt_pk_bf16_f32 v151, v214, v215
    v_cndmask_b32 v150, 0, v150, s[78:79]
    v_cndmask_b32 v151, 0, v151, s[78:79]
    v_mfma_f32_32x32x16_bf16 v[120:135], v[52:55], v[64:67], v[120:135]
    ds_write_b128 v251, v[144:147] offset:10240
    ds_write_b128 v251, v[148:151] offset:11264
    s_mov_b64 exec, 1
    ds_add_u32 v13, v249 offset:4
    s_mov_b64 exec, -1
    v_mfma_f32_32x32x16_bf16 v[184:199], v[48:51], v[64:67], v[184:199]
    v_mov_b64 v[72:73], 0
    v_mov_b64 v[74:75], 0
    v_mov_b64 v[76:77], 0
    v_mov_b64 v[78:79], 0
    v_mov_b64 v[80:81], 0
    s_waitcnt lgkmcnt(3)
    v_mfma_f32_32x32x16_bf16 v[104:119], v[68:71], v[60:63], v[104:119]
    v_mov_b64 v[82:83], 0
    v_mov_b64 v[84:85], 0
    v_mov_b64 v[86:87], 0
    v_mov_b64 v[88:89], 0
    v_mov_b64 v[90:91], 0
    v_mfma_f32_32x32x16_bf16 v[168:183], v[24:27], v[60:63], v[168:183]
    v_mov_b64 v[92:93], 0
    v_mov_b64 v[94:95], 0
    v_mov_b32 v2, v250
    ds_read_b32 v250, v13 offset:4
    v_mov_b64 v[96:97], 0
    v_mov_b64 v[98:99], 0
    v_mfma_f32_32x32x16_bf16 v[120:135], v[68:71], v[16:19], v[120:135]
    v_mov_b64 v[100:101], 0
    v_mov_b64 v[102:103], 0
    v_mfma_f32_32x32x16_bf16 v[184:199], v[24:27], v[16:19], v[184:199]
    s_cmp_lg_u32 s54, 0
    s_cbranch_scc0 SL15
SL15B:
    s_waitcnt lgkmcnt(0)
    v_readfirstlane_b32 s70, v250
    s_cmp_ge_u32 s70, 4
    s_cbranch_scc0 SL17
SL17B:
    v_add_u32 v252, s80, v1
    v_add_u32 v253, s81, v1
    v_add_u32 v254, s82, v1
    v_add_u32 v255, s83, v1
    ds_read_b128 v[136:139], v252
    ds_read_b128 v[140:143], v252 offset:1024
    ds_read_b128 v[144:147], v253
    ds_read_b128 v[148:151], v253 offset:1024
    ds_read_b128 v[152:155], v254
    ds_read_b128 v[156:159], v254 offset:1024
    ds_read_b128 v[160:163], v255
    ds_read_b128 v[164:167], v255 offset:1024
    v_mov_b32 v11, 2
    v_mov_b64 v[68:69], 0
    v_mov_b64 v[70:71], 0
    v_mov_b64 v[28:29], 0
    v_mov_b64 v[30:31], 0
    v_pk_mul_f32 v[104:105], v[104:105], v[168:169]
    v_pk_mul_f32 v[106:107], v[106:107], v[170:171]
    v_pk_mul_f32 v[108:109], v[108:109], v[172:173]
    v_pk_mul_f32 v[110:111], v[110:111], v[174:175]
    v_pk_mul_f32 v[112:113], v[112:113], v[176:177]
    v_pk_mul_f32 v[114:115], v[114:115], v[178:179]
    v_pk_mul_f32 v[116:117], v[116:117], v[180:181]
    v_pk_mul_f32 v[118:119], v[118:119], v[182:183]
    v_cvt_pk_bf16_f32 v40, v104, v105
    v_cvt_pk_bf16_f32 v41, v106, v107
    v_cvt_pk_bf16_f32 v42, v108, v109
    v_cvt_pk_bf16_f32 v43, v110, v111
    ds_write_b128 v251, v[40:43] offset:4096
    v_cvt_pk_bf16_f32 v44, v112, v113
    v_cvt_pk_bf16_f32 v45, v114, v115
    v_cvt_pk_bf16_f32 v46, v116, v117
    v_cvt_pk_bf16_f32 v47, v118, v119
    ds_write_b128 v251, v[44:47] offset:5120
    s_waitcnt vmcnt(5)
    s_waitcnt lgkmcnt(9)
    v_mfma_f32_32x32x16_bf16 v[200:215], v[216:219], v[136:139], 0
    v_pk_mul_f32 v[120:121], v[120:121], v[184:185]
    v_pk_mul_f32 v[122:123], v[122:123], v[186:187]
    v_pk_mul_f32 v[124:125], v[124:125], v[188:189]
    v_pk_mul_f32 v[126:127], v[126:127], v[190:191]
    v_pk_mul_f32 v[128:129], v[128:129], v[192:193]
    v_pk_mul_f32 v[130:131], v[130:131], v[194:195]
    s_waitcnt lgkmcnt(8)
    v_mfma_f32_32x32x16_bf16 v[200:215], v[220:223], v[140:143], v[200:215]
    v_pk_mul_f32 v[132:133], v[132:133], v[196:197]
    v_pk_mul_f32 v[134:135], v[134:135], v[198:199]
    v_cvt_pk_bf16_f32 v48, v120, v121
    v_cvt_pk_bf16_f32 v49, v122, v123
    v_cvt_pk_bf16_f32 v50, v124, v125
    v_cvt_pk_bf16_f32 v51, v126, v127
    ds_write_b128 v251, v[48:51] offset:6144
    v_cvt_pk_bf16_f32 v52, v128, v129
    v_cvt_pk_bf16_f32 v53, v130, v131
    v_cvt_pk_bf16_f32 v54, v132, v133
    v_cvt_pk_bf16_f32 v55, v134, v135
    ds_write_b128 v251, v[52:55] offset:7168
    ds_write_b32 v15, v11 offset:16
    s_mov_b64 exec, 1
    ds_add_u32 v13, v249 offset:8
    s_mov_b64 exec, -1
    v_mov_b64 v[104:105], 0
    v_mov_b64 v[106:107], 0
    v_mov_b64 v[108:109], 0
    v_mov_b64 v[110:111], 0
    v_mov_b64 v[112:113], 0
    v_mov_b64 v[114:115], 0
    v_mov_b64 v[116:117], 0
    v_mov_b64 v[118:119], 0
    v_mov_b64 v[120:121], 0
    v_mov_b64 v[122:123], 0
    v_mov_b64 v[124:125], 0
    v_mov_b64 v[126:127], 0
    v_mov_b64 v[128:129], 0
    v_mov_b64 v[130:131], 0
    v_mov_b64 v[132:133], 0
    v_mov_b64 v[134:135], 0
    v_mov_b32 v2, v140
    s_waitcnt lgkmcnt(10)
    v_mov_b32 v2, v148
    s_waitcnt lgkmcnt(8)
    v_mov_b32 v2, v156
    s_waitcnt lgkmcnt(6)
    v_mov_b32 v2, v164
ATT:
    s_mov_b32 s75, 4
ATT_LOOP:
    v_exp_f32 v200, v200
    v_exp_f32 v201, v201
    v_mfma_f32_32x32x16_bf16 v[120:135], v[28:31], v[68:71], v[120:135]
    buffer_load_dwordx4 v[16:19], v1, s[52:55], s73 offen offset:0 sc1
    buffer_load_dwordx4 v[20:23], v1, s[52:55], s73 offen offset:1024 sc1
    buffer_load_dwordx4 v[24:27], v1, s[52:55], s73 offen offset:2048 sc1
    buffer_load_dwordx4 v[28:31], v1, s[52:55], s73 offen offset:3072 sc1
    s_add_u32 s73, s73, 4096
    v_exp_f32 v202, v202
    v_cvt_pk_bf16_f32 v64, v200, v201
    v_exp_f32 v203, v203
    v_exp_f32 v204, v204
    v_cvt_pk_bf16_f32 v65, v202, v203
    v_exp_f32 v205, v205
    v_exp_f32 v206, v206
    v_mfma_f32_32x32x16_bf16 v[184:199], v[216:219], v[144:147], 0
    v_cvt_pk_bf16_f32 v66, v204, v205
    v_exp_f32 v207, v207
    v_exp_f32 v208, v208
    v_cvt_pk_bf16_f32 v67, v206, v207
    v_mfma_f32_32x32x16_bf16 v[184:199], v[220:223], v[148:151], v[184:199]
    v_exp_f32 v209, v209
    v_exp_f32 v210, v210
    v_cvt_pk_bf16_f32 v68, v208, v209
    v_exp_f32 v211, v211
    v_exp_f32 v212, v212
    v_cvt_pk_bf16_f32 v69, v210, v211
    v_exp_f32 v213, v213
    v_exp_f32 v214, v214
    v_exp_f32 v215, v215
    v_mfma_f32_32x32x16_bf16 v[72:87], v[224:227], v[64:67], v[72:87]
    v_cvt_pk_bf16_f32 v70, v212, v213
    v_cvt_pk_bf16_f32 v71, v214, v215
    v_exp_f32 v184, v184
    v_exp_f32 v185, v185
    v_mfma_f32_32x32x16_bf16 v[72:87], v[228:231], v[68:71], v[72:87]
    v_exp_f32 v186, v186
    v_cvt_pk_bf16_f32 v64, v184, v185
    v_exp_f32 v187, v187
    v_exp_f32 v188, v188
    v_cvt_pk_bf16_f32 v65, v186, v187
    v_exp_f32 v189, v189
    v_exp_f32 v190, v190
    v_mfma_f32_32x32x16_bf16 v[200:215], v[216:219], v[152:155], 0
    v_cvt_pk_bf16_f32 v66, v188, v189
    v_exp_f32 v191, v191
    v_exp_f32 v192, v192
    v_cvt_pk_bf16_f32 v67, v190, v191
    v_mfma_f32_32x32x16_bf16 v[200:215], v[220:223], v[156:159], v[200:215]
    v_exp_f32 v193, v193
    v_exp_f32 v194, v194
    v_cvt_pk_bf16_f32 v68, v192, v193
    v_exp_f32 v195, v195
    v_exp_f32 v196, v196
    v_cvt_pk_bf16_f32 v69, v194, v195
    v_exp_f32 v197, v197
    v_exp_f32 v198, v198
    v_exp_f32 v199, v199
    v_mfma_f32_32x32x16_bf16 v[88:103], v[224:227], v[64:67], v[88:103]
    v_cvt_pk_bf16_f32 v70, v196, v197
    v_cvt_pk_bf16_f32 v71, v198, v199
    v_exp_f32 v200, v200
    v_exp_f32 v201, v201
    v_mfma_f32_32x32x16_bf16 v[88:103], v[228:231], v[68:71], v[88:103]
    v_exp_f32 v202, v202
    v_cvt_pk_bf16_f32 v64, v200, v201
    v_exp_f32 v203, v203
    v_exp_f32 v204, v204
    v_cvt_pk_bf16_f32 v65, v202, v203
    v_exp_f32 v205, v205
    v_exp_f32 v206, v206
    v_mfma_f32_32x32x16_bf16 v[184:199], v[216:219], v[160:163], 0
    v_cvt_pk_bf16_f32 v66, v204, v205
    v_exp_f32 v207, v207
    v_exp_f32 v208, v208
    v_cvt_pk_bf16_f32 v67, v206, v207
    v_mfma_f32_32x32x16_bf16 v[184:199], v[220:223], v[164:167], v[184:199]
    v_exp_f32 v209, v209
    v_exp_f32 v210, v210
    v_cvt_pk_bf16_f32 v68, v208, v209
    v_exp_f32 v211, v211
    v_exp_f32 v212, v212
    v_cvt_pk_bf16_f32 v69, v210, v211
    v_exp_f32 v213, v213
    v_exp_f32 v214, v214
    v_exp_f32 v215, v215
    v_mfma_f32_32x32x16_bf16 v[104:119], v[224:227], v[64:67], v[104:119]
    v_cvt_pk_bf16_f32 v70, v212, v213
    v_cvt_pk_bf16_f32 v71, v214, v215
    v_exp_f32 v184, v184
    v_exp_f32 v185, v185
    v_mfma_f32_32x32x16_bf16 v[104:119], v[228:231], v[68:71], v[104:119]
    v_exp_f32 v186, v186
    v_cvt_pk_bf16_f32 v64, v184, v185
    v_exp_f32 v187, v187
    v_exp_f32 v188, v188
    v_cvt_pk_bf16_f32 v65, v186, v187
    v_exp_f32 v189, v189
    v_exp_f32 v190, v190
    s_waitcnt vmcnt(4)
    v_mfma_f32_32x32x16_bf16 v[200:215], v[232:235], v[136:139], 0
    v_cvt_pk_bf16_f32 v66, v188, v189
    v_exp_f32 v191, v191
    v_exp_f32 v192, v192
    v_cvt_pk_bf16_f32 v67, v190, v191
    v_mfma_f32_32x32x16_bf16 v[200:215], v[236:239], v[140:143], v[200:215]
    v_exp_f32 v193, v193
    v_exp_f32 v194, v194
    v_cvt_pk_bf16_f32 v68, v192, v193
    v_exp_f32 v195, v195
    v_exp_f32 v196, v196
    v_cvt_pk_bf16_f32 v69, v194, v195
    v_exp_f32 v197, v197
    v_exp_f32 v198, v198
    v_exp_f32 v199, v199
    v_mfma_f32_32x32x16_bf16 v[120:135], v[224:227], v[64:67], v[120:135]
    v_cvt_pk_bf16_f32 v70, v196, v197
    v_cvt_pk_bf16_f32 v71, v198, v199
    v_exp_f32 v200, v200
    v_exp_f32 v201, v201
    v_mfma_f32_32x32x16_bf16 v[120:135], v[228:231], v[68:71], v[120:135]
    buffer_load_dwordx4 v[216:219], v1, s[52:55], s73 offen offset:0 sc1
    buffer_load_dwordx4 v[220:223], v1, s[52:55], s73 offen offset:1024 sc1
    buffer_load_dwordx4 v[224:227], v1, s[52:55], s73 offen offset:2048 sc1
    buffer_load_dwordx4 v[228:231], v1, s[52:55], s73 offen offset:3072 sc1
    s_add_u32 s73, s73, 4096
    v_exp_f32 v202, v202
    v_cvt_pk_bf16_f32 v64, v200, v201
    v_exp_f32 v203, v203
    v_exp_f32 v204, v204
    v_cvt_pk_bf16_f32 v65, v202, v203
    v_exp_f32 v205, v205
    v_exp_f32 v206, v206
    v_mfma_f32_32x32x16_bf16 v[184:199], v[232:235], v[144:147], 0
    v_cvt_pk_bf16_f32 v66, v204, v205
    v_exp_f32 v207, v207
    v_exp_f32 v208, v208
    v_cvt_pk_bf16_f32 v67, v206, v207
    v_mfma_f32_32x32x16_bf16 v[184:199], v[236:239], v[148:151], v[184:199]
    v_exp_f32 v209, v209
    v_exp_f32 v210, v210
    v_cvt_pk_bf16_f32 v68, v208, v209
    v_exp_f32 v211, v211
    v_exp_f32 v212, v212
    v_cvt_pk_bf16_f32 v69, v210, v211
    v_exp_f32 v213, v213
    v_exp_f32 v214, v214
    v_exp_f32 v215, v215
    v_mfma_f32_32x32x16_bf16 v[72:87], v[240:243], v[64:67], v[72:87]
    v_cvt_pk_bf16_f32 v70, v212, v213
    v_cvt_pk_bf16_f32 v71, v214, v215
    v_exp_f32 v184, v184
    v_exp_f32 v185, v185
    v_mfma_f32_32x32x16_bf16 v[72:87], v[244:247], v[68:71], v[72:87]
    v_exp_f32 v186, v186
    v_cvt_pk_bf16_f32 v64, v184, v185
    v_exp_f32 v187, v187
    v_exp_f32 v188, v188
    v_cvt_pk_bf16_f32 v65, v186, v187
    v_exp_f32 v189, v189
    v_exp_f32 v190, v190
    v_mfma_f32_32x32x16_bf16 v[200:215], v[232:235], v[152:155], 0
    v_cvt_pk_bf16_f32 v66, v188, v189
    v_exp_f32 v191, v191
    v_exp_f32 v192, v192
    v_cvt_pk_bf16_f32 v67, v190, v191
    v_mfma_f32_32x32x16_bf16 v[200:215], v[236:239], v[156:159], v[200:215]
    v_exp_f32 v193, v193
    v_exp_f32 v194, v194
    v_cvt_pk_bf16_f32 v68, v192, v193
    v_exp_f32 v195, v195
    v_exp_f32 v196, v196
    v_cvt_pk_bf16_f32 v69, v194, v195
    v_exp_f32 v197, v197
    v_exp_f32 v198, v198
    v_exp_f32 v199, v199
    v_mfma_f32_32x32x16_bf16 v[88:103], v[240:243], v[64:67], v[88:103]
    v_cvt_pk_bf16_f32 v70, v196, v197
    v_cvt_pk_bf16_f32 v71, v198, v199
    v_exp_f32 v200, v200
    v_exp_f32 v201, v201
    v_mfma_f32_32x32x16_bf16 v[88:103], v[244:247], v[68:71], v[88:103]
    v_exp_f32 v202, v202
    v_cvt_pk_bf16_f32 v64, v200, v201
    v_exp_f32 v203, v203
    v_exp_f32 v204, v204
    v_cvt_pk_bf16_f32 v65, v202, v203
    v_exp_f32 v205, v205
    v_exp_f32 v206, v206
    v_mfma_f32_32x32x16_bf16 v[184:199], v[232:235], v[160:163], 0
    v_cvt_pk_bf16_f32 v66, v204, v205
    v_exp_f32 v207, v207
    v_exp_f32 v208, v208
    v_cvt_pk_bf16_f32 v67, v206, v207
    v_mfma_f32_32x32x16_bf16 v[184:199], v[236:239], v[164:167], v[184:199]
    v_exp_f32 v209, v209
    v_exp_f32 v210, v210
    v_cvt_pk_bf16_f32 v68, v208, v209
    v_exp_f32 v211, v211
    v_exp_f32 v212, v212
    v_cvt_pk_bf16_f32 v69, v210, v211
    v_exp_f32 v213, v213
    v_exp_f32 v214, v214
    v_exp_f32 v215, v215
    v_mfma_f32_32x32x16_bf16 v[104:119], v[240:243], v[64:67], v[104:119]
    v_cvt_pk_bf16_f32 v70, v212, v213
    v_cvt_pk_bf16_f32 v71, v214, v215
    v_exp_f32 v184, v184
    v_exp_f32 v185, v185
    v_mfma_f32_32x32x16_bf16 v[104:119], v[244:247], v[68:71], v[104:119]
    v_exp_f32 v186, v186
    v_cvt_pk_bf16_f32 v64, v184, v185
    v_exp_f32 v187, v187
    v_exp_f32 v188, v188
    v_cvt_pk_bf16_f32 v65, v186, v187
    v_exp_f32 v189, v189
    v_exp_f32 v190, v190
    s_waitcnt vmcnt(4)
    v_mfma_f32_32x32x16_bf16 v[200:215], v[16:19], v[136:139], 0
    v_cvt_pk_bf16_f32 v66, v188, v189
    v_exp_f32 v191, v191
    v_exp_f32 v192, v192
    v_cvt_pk_bf16_f32 v67, v190, v191
    v_mfma_f32_32x32x16_bf16 v[200:215], v[20:23], v[140:143], v[200:215]
    v_exp_f32 v193, v193
    v_exp_f32 v194, v194
    v_cvt_pk_bf16_f32 v68, v192, v193
    v_exp_f32 v195, v195
    v_exp_f32 v196, v196
    v_cvt_pk_bf16_f32 v69, v194, v195
    v_exp_f32 v197, v197
    v_exp_f32 v198, v198
    v_exp_f32 v199, v199
    v_mfma_f32_32x32x16_bf16 v[120:135], v[240:243], v[64:67], v[120:135]
    v_cvt_pk_bf16_f32 v70, v196, v197
    v_cvt_pk_bf16_f32 v71, v198, v199
    v_exp_f32 v200, v200
    v_exp_f32 v201, v201
    v_mfma_f32_32x32x16_bf16 v[120:135], v[244:247], v[68:71], v[120:135]
    buffer_load_dwordx4 v[232:235], v1, s[52:55], s73 offen offset:0 sc1
    buffer_load_dwordx4 v[236:239], v1, s[52:55], s73 offen offset:1024 sc1
    buffer_load_dwordx4 v[240:243], v1, s[52:55], s73 offen offset:2048 sc1
    buffer_load_dwordx4 v[244:247], v1, s[52:55], s73 offen offset:3072 sc1
    s_add_u32 s73, s73, 4096
    v_exp_f32 v202, v202
    v_cvt_pk_bf16_f32 v64, v200, v201
    v_exp_f32 v203, v203
    v_exp_f32 v204, v204
    v_cvt_pk_bf16_f32 v65, v202, v203
    v_exp_f32 v205, v205
    v_exp_f32 v206, v206
    v_mfma_f32_32x32x16_bf16 v[184:199], v[16:19], v[144:147], 0
    v_cvt_pk_bf16_f32 v66, v204, v205
    v_exp_f32 v207, v207
    v_exp_f32 v208, v208
    v_cvt_pk_bf16_f32 v67, v206, v207
    v_mfma_f32_32x32x16_bf16 v[184:199], v[20:23], v[148:151], v[184:199]
    v_exp_f32 v209, v209
    v_exp_f32 v210, v210
    v_cvt_pk_bf16_f32 v68, v208, v209
    v_exp_f32 v211, v211
    v_exp_f32 v212, v212
    v_cvt_pk_bf16_f32 v69, v210, v211
    v_exp_f32 v213, v213
    v_exp_f32 v214, v214
    v_exp_f32 v215, v215
    v_mfma_f32_32x32x16_bf16 v[72:87], v[24:27], v[64:67], v[72:87]
    v_cvt_pk_bf16_f32 v70, v212, v213
    v_cvt_pk_bf16_f32 v71, v214, v215
    v_exp_f32 v184, v184
    v_exp_f32 v185, v185
    v_mfma_f32_32x32x16_bf16 v[72:87], v[28:31], v[68:71], v[72:87]
    v_exp_f32 v186, v186
    v_cvt_pk_bf16_f32 v64, v184, v185
    v_exp_f32 v187, v187
    v_exp_f32 v188, v188
    v_cvt_pk_bf16_f32 v65, v186, v187
    v_exp_f32 v189, v189
    v_exp_f32 v190, v190
    v_mfma_f32_32x32x16_bf16 v[200:215], v[16:19], v[152:155], 0
    v_cvt_pk_bf16_f32 v66, v188, v189
    v_exp_f32 v191, v191
    v_exp_f32 v192, v192
    v_cvt_pk_bf16_f32 v67, v190, v191
    v_mfma_f32_32x32x16_bf16 v[200:215], v[20:23], v[156:159], v[200:215]
    v_exp_f32 v193, v193
    v_exp_f32 v194, v194
    v_cvt_pk_bf16_f32 v68, v192, v193
    v_exp_f32 v195, v195
    v_exp_f32 v196, v196
    v_cvt_pk_bf16_f32 v69, v194, v195
    v_exp_f32 v197, v197
    v_exp_f32 v198, v198
    v_exp_f32 v199, v199
    v_mfma_f32_32x32x16_bf16 v[88:103], v[24:27], v[64:67], v[88:103]
    v_cvt_pk_bf16_f32 v70, v196, v197
    v_cvt_pk_bf16_f32 v71, v198, v199
    v_exp_f32 v200, v200
    v_exp_f32 v201, v201
    v_mfma_f32_32x32x16_bf16 v[88:103], v[28:31], v[68:71], v[88:103]
    v_exp_f32 v202, v202
    v_cvt_pk_bf16_f32 v64, v200, v201
    v_exp_f32 v203, v203
    v_exp_f32 v204, v204
    v_cvt_pk_bf16_f32 v65, v202, v203
    v_exp_f32 v205, v205
    v_exp_f32 v206, v206
    v_mfma_f32_32x32x16_bf16 v[184:199], v[16:19], v[160:163], 0
    v_cvt_pk_bf16_f32 v66, v204, v205
    v_exp_f32 v207, v207
    v_exp_f32 v208, v208
    v_cvt_pk_bf16_f32 v67, v206, v207
    v_mfma_f32_32x32x16_bf16 v[184:199], v[20:23], v[164:167], v[184:199]
    v_exp_f32 v209, v209
    v_exp_f32 v210, v210
    v_cvt_pk_bf16_f32 v68, v208, v209
    v_exp_f32 v211, v211
    v_exp_f32 v212, v212
    v_cvt_pk_bf16_f32 v69, v210, v211
    v_exp_f32 v213, v213
    v_exp_f32 v214, v214
    v_exp_f32 v215, v215
    v_mfma_f32_32x32x16_bf16 v[104:119], v[24:27], v[64:67], v[104:119]
    v_cvt_pk_bf16_f32 v70, v212, v213
    v_cvt_pk_bf16_f32 v71, v214, v215
    v_exp_f32 v184, v184
    v_exp_f32 v185, v185
    v_mfma_f32_32x32x16_bf16 v[104:119], v[28:31], v[68:71], v[104:119]
    v_exp_f32 v186, v186
    v_cvt_pk_bf16_f32 v64, v184, v185
    v_exp_f32 v187, v187
    v_exp_f32 v188, v188
    v_cvt_pk_bf16_f32 v65, v186, v187
    v_exp_f32 v189, v189
    v_exp_f32 v190, v190
    s_waitcnt vmcnt(4)
    v_mfma_f32_32x32x16_bf16 v[200:215], v[216:219], v[136:139], 0
    v_cvt_pk_bf16_f32 v66, v188, v189
    v_exp_f32 v191, v191
    v_exp_f32 v192, v192
    v_cvt_pk_bf16_f32 v67, v190, v191
    v_mfma_f32_32x32x16_bf16 v[200:215], v[220:223], v[140:143], v[200:215]
    v_exp_f32 v193, v193
    v_exp_f32 v194, v194
    v_cvt_pk_bf16_f32 v68, v192, v193
    v_exp_f32 v195, v195
    v_exp_f32 v196, v196
    v_cvt_pk_bf16_f32 v69, v194, v195
    v_exp_f32 v197, v197
    v_exp_f32 v198, v198
    v_exp_f32 v199, v199
    v_mfma_f32_32x32x16_bf16 v[120:135], v[24:27], v[64:67], v[120:135]
    s_sub_u32 s75, s75, 1
    v_cvt_pk_bf16_f32 v70, v196, v197
    v_cvt_pk_bf16_f32 v71, v198, v199
    s_cmp_lg_u32 s75, 0
    s_cbranch_scc1 ATT_LOOP
    v_exp_f32 v200, v200
    v_exp_f32 v201, v201
    v_mfma_f32_32x32x16_bf16 v[120:135], v[28:31], v[68:71], v[120:135]
    buffer_load_dwordx4 v[16:19], v1, s[52:55], s73 offen offset:0 sc1
    buffer_load_dwordx4 v[20:23], v1, s[52:55], s73 offen offset:1024 sc1
    buffer_load_dwordx4 v[24:27], v1, s[52:55], s73 offen offset:2048 sc1
    buffer_load_dwordx4 v[28:31], v1, s[52:55], s73 offen offset:3072 sc1
    s_add_u32 s73, s73, 4096
    v_exp_f32 v202, v202
    v_cvt_pk_bf16_f32 v64, v200, v201
    v_exp_f32 v203, v203
    v_exp_f32 v204, v204
    v_cvt_pk_bf16_f32 v65, v202, v203
    v_exp_f32 v205, v205
    v_exp_f32 v206, v206
    v_mfma_f32_32x32x16_bf16 v[184:199], v[216:219], v[144:147], 0
    v_cvt_pk_bf16_f32 v66, v204, v205
    v_exp_f32 v207, v207
    v_exp_f32 v208, v208
    v_cvt_pk_bf16_f32 v67, v206, v207
    v_mfma_f32_32x32x16_bf16 v[184:199], v[220:223], v[148:151], v[184:199]
    v_exp_f32 v209, v209
    v_exp_f32 v210, v210
    v_cvt_pk_bf16_f32 v68, v208, v209
    v_exp_f32 v211, v211
    v_exp_f32 v212, v212
    v_cvt_pk_bf16_f32 v69, v210, v211
    v_exp_f32 v213, v213
    v_exp_f32 v214, v214
    v_exp_f32 v215, v215
    v_mfma_f32_32x32x16_bf16 v[72:87], v[224:227], v[64:67], v[72:87]
    buffer_load_dwordx4 v[32:35], v1, s[52:55], s73 offen offset:0 sc1
    buffer_load_dwordx4 v[36:39], v1, s[52:55], s73 offen offset:1024 sc1
    buffer_load_dwordx4 v[40:43], v1, s[52:55], s73 offen offset:2048 sc1
    buffer_load_dwordx4 v[44:47], v1, s[52:55], s73 offen offset:3072 sc1
    v_cvt_pk_bf16_f32 v70, v212, v213
    v_cvt_pk_bf16_f32 v71, v214, v215
    v_exp_f32 v184, v184
    v_exp_f32 v185, v185
    v_mfma_f32_32x32x16_bf16 v[72:87], v[228:231], v[68:71], v[72:87]
    v_add_u32 v4, s40, v1
    v_exp_f32 v186, v186
    v_cvt_pk_bf16_f32 v64, v184, v185
    v_exp_f32 v187, v187
    v_exp_f32 v188, v188
    v_cvt_pk_bf16_f32 v65, v186, v187
    v_exp_f32 v189, v189
    v_exp_f32 v190, v190
    v_mfma_f32_32x32x16_bf16 v[200:215], v[216:219], v[152:155], 0
    v_add_u32 v5, s41, v1
    v_cvt_pk_bf16_f32 v66, v188, v189
    v_exp_f32 v191, v191
    v_exp_f32 v192, v192
    v_cvt_pk_bf16_f32 v67, v190, v191
    v_mfma_f32_32x32x16_bf16 v[200:215], v[220:223], v[156:159], v[200:215]
    v_add_u32 v6, s42, v1
    v_exp_f32 v193, v193
    v_exp_f32 v194, v194
    v_cvt_pk_bf16_f32 v68, v192, v193
    v_exp_f32 v195, v195
    v_exp_f32 v196, v196
    v_cvt_pk_bf16_f32 v69, v194, v195
    v_exp_f32 v197, v197
    v_exp_f32 v198, v198
    v_exp_f32 v199, v199
    v_mfma_f32_32x32x16_bf16 v[88:103], v[224:227], v[64:67], v[88:103]
    v_add_u32 v7, s43, v1
    v_cvt_pk_bf16_f32 v70, v196, v197
    v_cvt_pk_bf16_f32 v71, v198, v199
    v_exp_f32 v200, v200
    v_exp_f32 v201, v201
    v_mfma_f32_32x32x16_bf16 v[88:103], v[228:231], v[68:71], v[88:103]
    v_mov_b32 v13, 159744
    v_exp_f32 v202, v202
    v_cvt_pk_bf16_f32 v64, v200, v201
    v_exp_f32 v203, v203
    v_exp_f32 v204, v204
    v_cvt_pk_bf16_f32 v65, v202, v203
    v_exp_f32 v205, v205
    v_exp_f32 v206, v206
    s_waitcnt vmcnt(8)
    v_mfma_f32_32x32x16_bf16 v[184:199], v[232:235], v[136:139], 0
    v_cvt_pk_bf16_f32 v66, v204, v205
    v_exp_f32 v207, v207
    v_exp_f32 v208, v208
    v_cvt_pk_bf16_f32 v67, v206, v207
    v_mfma_f32_32x32x16_bf16 v[184:199], v[236:239], v[140:143], v[184:199]
    v_exp_f32 v209, v209
    v_exp_f32 v210, v210
    v_cvt_pk_bf16_f32 v68, v208, v209
    v_exp_f32 v211, v211
    v_exp_f32 v212, v212
    v_cvt_pk_bf16_f32 v69, v210, v211
    v_exp_f32 v213, v213
    v_exp_f32 v214, v214
    v_exp_f32 v215, v215
    v_mfma_f32_32x32x16_bf16 v[104:119], v[224:227], v[64:67], v[104:119]
    v_mov_b32 v12, 1
    v_cvt_pk_bf16_f32 v70, v212, v213
    v_cvt_pk_bf16_f32 v71, v214, v215
    v_exp_f32 v184, v184
    v_exp_f32 v185, v185
    v_mfma_f32_32x32x16_bf16 v[104:119], v[228:231], v[68:71], v[104:119]
    v_exp_f32 v186, v186
    v_cvt_pk_bf16_f32 v64, v184, v185
    v_exp_f32 v187, v187
    v_exp_f32 v188, v188
    v_cvt_pk_bf16_f32 v65, v186, v187
    v_exp_f32 v189, v189
    v_exp_f32 v190, v190
    v_mfma_f32_32x32x16_bf16 v[200:215], v[232:235], v[144:147], 0
    v_cvt_pk_bf16_f32 v66, v188, v189
    v_exp_f32 v191, v191
    v_exp_f32 v192, v192
    v_cvt_pk_bf16_f32 v67, v190, v191
    v_mfma_f32_32x32x16_bf16 v[200:215], v[236:239], v[148:151], v[200:215]
    v_exp_f32 v193, v193
    v_exp_f32 v194, v194
    v_cvt_pk_bf16_f32 v68, v192, v193
    v_exp_f32 v195, v195
    v_exp_f32 v196, v196
    v_cvt_pk_bf16_f32 v69, v194, v195
    v_exp_f32 v197, v197
    v_exp_f32 v198, v198
    v_exp_f32 v199, v199
    v_mfma_f32_32x32x16_bf16 v[72:87], v[240:243], v[64:67], v[72:87]
    v_cvt_pk_bf16_f32 v70, v196, v197
    v_cvt_pk_bf16_f32 v71, v198, v199
    v_exp_f32 v200, v200
    v_exp_f32 v201, v201
    v_mfma_f32_32x32x16_bf16 v[72:87], v[244:247], v[68:71], v[72:87]
    v_exp_f32 v202, v202
    v_cvt_pk_bf16_f32 v64, v200, v201
    v_exp_f32 v203, v203
    v_exp_f32 v204, v204
    v_cvt_pk_bf16_f32 v65, v202, v203
    v_exp_f32 v205, v205
    v_exp_f32 v206, v206
    v_mfma_f32_32x32x16_bf16 v[184:199], v[232:235], v[152:155], 0
    v_cvt_pk_bf16_f32 v66, v204, v205
    v_exp_f32 v207, v207
    v_exp_f32 v208, v208
    v_cvt_pk_bf16_f32 v67, v206, v207
    v_mfma_f32_32x32x16_bf16 v[184:199], v[236:239], v[156:159], v[184:199]
    v_exp_f32 v209, v209
    v_exp_f32 v210, v210
    v_cvt_pk_bf16_f32 v68, v208, v209
    v_exp_f32 v211, v211
    v_exp_f32 v212, v212
    v_cvt_pk_bf16_f32 v69, v210, v211
    v_exp_f32 v213, v213
    v_exp_f32 v214, v214
    v_exp_f32 v215, v215
    v_mfma_f32_32x32x16_bf16 v[88:103], v[240:243], v[64:67], v[88:103]
    v_cvt_pk_bf16_f32 v70, v212, v213
    v_cvt_pk_bf16_f32 v71, v214, v215
    v_exp_f32 v184, v184
    v_exp_f32 v185, v185
    v_mfma_f32_32x32x16_bf16 v[88:103], v[244:247], v[68:71], v[88:103]
    v_exp_f32 v186, v186
    v_cvt_pk_bf16_f32 v64, v184, v185
    v_exp_f32 v187, v187
    v_exp_f32 v188, v188
    v_cvt_pk_bf16_f32 v65, v186, v187
    v_exp_f32 v189, v189
    v_exp_f32 v190, v190
    s_waitcnt vmcnt(4)
    v_mfma_f32_32x32x16_bf16 v[200:215], v[16:19], v[136:139], 0
    v_cvt_pk_bf16_f32 v66, v188, v189
    v_exp_f32 v191, v191
    v_exp_f32 v192, v192
    v_cvt_pk_bf16_f32 v67, v190, v191
    v_mfma_f32_32x32x16_bf16 v[200:215], v[20:23], v[140:143], v[200:215]
    v_exp_f32 v193, v193
    v_exp_f32 v194, v194
    v_cvt_pk_bf16_f32 v68, v192, v193
    v_exp_f32 v195, v195
    v_exp_f32 v196, v196
    v_cvt_pk_bf16_f32 v69, v194, v195
    v_exp_f32 v197, v197
    v_exp_f32 v198, v198
    v_exp_f32 v199, v199
    v_mfma_f32_32x32x16_bf16 v[104:119], v[240:243], v[64:67], v[104:119]
    v_cvt_pk_bf16_f32 v70, v196, v197
    v_cvt_pk_bf16_f32 v71, v198, v199
    v_exp_f32 v200, v200
    v_exp_f32 v201, v201
    v_mfma_f32_32x32x16_bf16 v[104:119], v[244:247], v[68:71], v[104:119]
    v_exp_f32 v202, v202
    v_cvt_pk_bf16_f32 v64, v200, v201
    v_exp_f32 v203, v203
    v_exp_f32 v204, v204
    v_cvt_pk_bf16_f32 v65, v202, v203
    v_exp_f32 v205, v205
    v_exp_f32 v206, v206
    v_mfma_f32_32x32x16_bf16 v[184:199], v[16:19], v[144:147], 0
    v_cvt_pk_bf16_f32 v66, v204, v205
    v_exp_f32 v207, v207
    v_exp_f32 v208, v208
    v_cvt_pk_bf16_f32 v67, v206, v207
    v_mfma_f32_32x32x16_bf16 v[184:199], v[20:23], v[148:151], v[184:199]
    v_exp_f32 v209, v209
    v_exp_f32 v210, v210
    v_cvt_pk_bf16_f32 v68, v208, v209
    v_exp_f32 v211, v211
    v_exp_f32 v212, v212
    v_cvt_pk_bf16_f32 v69, v210, v211
    v_exp_f32 v213, v213
    v_exp_f32 v214, v214
    v_exp_f32 v215, v215
    v_mfma_f32_32x32x16_bf16 v[72:87], v[24:27], v[64:67], v[72:87]
    v_cvt_pk_bf16_f32 v70, v212, v213
    v_cvt_pk_bf16_f32 v71, v214, v215
    v_exp_f32 v184, v184
    v_exp_f32 v185, v185
    v_mfma_f32_32x32x16_bf16 v[72:87], v[28:31], v[68:71], v[72:87]
    v_exp_f32 v186, v186
    v_cvt_pk_bf16_f32 v64, v184, v185
    v_exp_f32 v187, v187
    v_exp_f32 v188, v188
    v_cvt_pk_bf16_f32 v65, v186, v187
    v_exp_f32 v189, v189
    v_exp_f32 v190, v190
    s_waitcnt vmcnt(0)
    v_mfma_f32_32x32x16_bf16 v[200:215], v[32:35], v[136:139], 0
    v_cvt_pk_bf16_f32 v66, v188, v189
    v_exp_f32 v191, v191
    v_exp_f32 v192, v192
    v_cvt_pk_bf16_f32 v67, v190, v191
    v_mfma_f32_32x32x16_bf16 v[200:215], v[36:39], v[140:143], v[200:215]
    v_exp_f32 v193, v193
    v_exp_f32 v194, v194
    v_cvt_pk_bf16_f32 v68, v192, v193
    v_exp_f32 v195, v195
    v_exp_f32 v196, v196
    v_cvt_pk_bf16_f32 v69, v194, v195
    v_exp_f32 v197, v197
    v_exp_f32 v198, v198
    v_exp_f32 v199, v199
    v_mfma_f32_32x32x16_bf16 v[88:103], v[24:27], v[64:67], v[88:103]
    v_cvt_pk_bf16_f32 v70, v196, v197
    v_cvt_pk_bf16_f32 v71, v198, v199
    v_exp_f32 v200, v200
    v_exp_f32 v201, v201
    v_mfma_f32_32x32x16_bf16 v[88:103], v[28:31], v[68:71], v[88:103]
    v_exp_f32 v202, v202
    v_cvt_pk_bf16_f32 v64, v200, v201
    v_exp_f32 v203, v203
    v_exp_f32 v204, v204
    v_cvt_pk_bf16_f32 v65, v202, v203
    v_exp_f32 v205, v205
    v_exp_f32 v206, v206
    v_mfma_f32_32x32x16_bf16 v[184:199], v[32:35], v[144:147], 0
    v_cvt_pk_bf16_f32 v66, v204, v205
    v_exp_f32 v207, v207
    v_exp_f32 v208, v208
    v_cvt_pk_bf16_f32 v67, v206, v207
    v_mfma_f32_32x32x16_bf16 v[184:199], v[36:39], v[148:151], v[184:199]
    v_exp_f32 v209, v209
    v_exp_f32 v210, v210
    v_cvt_pk_bf16_f32 v68, v208, v209
    v_exp_f32 v211, v211
    v_exp_f32 v212, v212
    v_cvt_pk_bf16_f32 v69, v210, v211
    v_exp_f32 v213, v213
    v_exp_f32 v214, v214
    v_exp_f32 v215, v215
    v_mfma_f32_32x32x16_bf16 v[72:87], v[40:43], v[64:67], v[72:87]
    v_cvt_pk_bf16_f32 v70, v212, v213
    v_cvt_pk_bf16_f32 v71, v214, v215
    v_exp_f32 v184, v184
    v_exp_f32 v185, v185
    v_mfma_f32_32x32x16_bf16 v[72:87], v[44:47], v[68:71], v[72:87]
    v_exp_f32 v186, v186
    v_cvt_pk_bf16_f32 v64, v184, v185
    v_exp_f32 v187, v187
    v_exp_f32 v188, v188
    v_cvt_pk_bf16_f32 v65, v186, v187
    v_exp_f32 v189, v189
    v_exp_f32 v190, v190
    v_mfma_f32_32x32x16_bf16 v[200:215], v[16:19], v[152:155], 0
    v_cvt_pk_bf16_f32 v66, v188, v189
    v_exp_f32 v191, v191
    v_exp_f32 v192, v192
    v_cvt_pk_bf16_f32 v67, v190, v191
    v_mfma_f32_32x32x16_bf16 v[200:215], v[20:23], v[156:159], v[200:215]
    v_exp_f32 v193, v193
    v_exp_f32 v194, v194
    v_cvt_pk_bf16_f32 v68, v192, v193
    v_exp_f32 v195, v195
    v_exp_f32 v196, v196
    v_cvt_pk_bf16_f32 v69, v194, v195
    v_exp_f32 v197, v197
    v_exp_f32 v198, v198
    v_exp_f32 v199, v199
    v_mfma_f32_32x32x16_bf16 v[88:103], v[40:43], v[64:67], v[88:103]
    v_cvt_pk_bf16_f32 v70, v196, v197
    v_cvt_pk_bf16_f32 v71, v198, v199
    v_exp_f32 v200, v200
    v_exp_f32 v201, v201
    v_mfma_f32_32x32x16_bf16 v[88:103], v[44:47], v[68:71], v[88:103]
    ds_write_b128 v4, v[72:75] offset:0
    v_exp_f32 v202, v202
    v_cvt_pk_bf16_f32 v64, v200, v201
    v_exp_f32 v203, v203
    v_exp_f32 v204, v204
    v_cvt_pk_bf16_f32 v65, v202, v203
    v_exp_f32 v205, v205
    v_exp_f32 v206, v206
    v_mfma_f32_32x32x16_bf16 v[184:199], v[32:35], v[152:155], 0
    ds_write_b128 v4, v[76:79] offset:1024
    v_cvt_pk_bf16_f32 v66, v204, v205
    v_exp_f32 v207, v207
    v_exp_f32 v208, v208
    v_cvt_pk_bf16_f32 v67, v206, v207
    v_mfma_f32_32x32x16_bf16 v[184:199], v[36:39], v[156:159], v[184:199]
    ds_write_b128 v4, v[80:83] offset:2048
    v_exp_f32 v209, v209
    v_exp_f32 v210, v210
    v_cvt_pk_bf16_f32 v68, v208, v209
    v_exp_f32 v211, v211
    v_exp_f32 v212, v212
    v_cvt_pk_bf16_f32 v69, v210, v211
    v_exp_f32 v213, v213
    v_exp_f32 v214, v214
    v_exp_f32 v215, v215
    v_mfma_f32_32x32x16_bf16 v[104:119], v[24:27], v[64:67], v[104:119]
    ds_write_b128 v4, v[84:87] offset:3072
    v_cvt_pk_bf16_f32 v70, v212, v213
    v_cvt_pk_bf16_f32 v71, v214, v215
    v_exp_f32 v184, v184
    v_exp_f32 v185, v185
    v_mfma_f32_32x32x16_bf16 v[104:119], v[28:31], v[68:71], v[104:119]
    ds_write_b128 v5, v[88:91] offset:0
    v_exp_f32 v186, v186
    v_cvt_pk_bf16_f32 v64, v184, v185
    v_exp_f32 v187, v187
    v_exp_f32 v188, v188
    v_cvt_pk_bf16_f32 v65, v186, v187
    v_exp_f32 v189, v189
    v_exp_f32 v190, v190
    v_mfma_f32_32x32x16_bf16 v[200:215], v[216:219], v[160:163], 0
    ds_write_b128 v5, v[92:95] offset:1024
    v_cvt_pk_bf16_f32 v66, v188, v189
    v_exp_f32 v191, v191
    v_exp_f32 v192, v192
    v_cvt_pk_bf16_f32 v67, v190, v191
    v_mfma_f32_32x32x16_bf16 v[200:215], v[220:223], v[164:167], v[200:215]
    ds_write_b128 v5, v[96:99] offset:2048
    v_exp_f32 v193, v193
    v_exp_f32 v194, v194
    v_cvt_pk_bf16_f32 v68, v192, v193
    v_exp_f32 v195, v195
    v_exp_f32 v196, v196
    v_cvt_pk_bf16_f32 v69, v194, v195
    v_exp_f32 v197, v197
    v_exp_f32 v198, v198
    v_exp_f32 v199, v199
    v_mfma_f32_32x32x16_bf16 v[104:119], v[40:43], v[64:67], v[104:119]
    ds_write_b128 v5, v[100:103] offset:3072
    v_cvt_pk_bf16_f32 v70, v196, v197
    v_cvt_pk_bf16_f32 v71, v198, v199
    v_exp_f32 v200, v200
    v_exp_f32 v201, v201
    v_mfma_f32_32x32x16_bf16 v[104:119], v[44:47], v[68:71], v[104:119]
    v_exp_f32 v202, v202
    v_cvt_pk_bf16_f32 v64, v200, v201
    v_exp_f32 v203, v203
    v_exp_f32 v204, v204
    v_cvt_pk_bf16_f32 v65, v202, v203
    v_exp_f32 v205, v205
    v_exp_f32 v206, v206
    v_mfma_f32_32x32x16_bf16 v[184:199], v[232:235], v[160:163], 0
    v_cvt_pk_bf16_f32 v66, v204, v205
    v_exp_f32 v207, v207
    v_exp_f32 v208, v208
    v_cvt_pk_bf16_f32 v67, v206, v207
    v_mfma_f32_32x32x16_bf16 v[184:199], v[236:239], v[164:167], v[184:199]
    v_exp_f32 v209, v209
    v_exp_f32 v210, v210
    v_cvt_pk_bf16_f32 v68, v208, v209
    v_exp_f32 v211, v211
    v_exp_f32 v212, v212
    v_cvt_pk_bf16_f32 v69, v210, v211
    v_exp_f32 v213, v213
    v_exp_f32 v214, v214
    v_exp_f32 v215, v215
    v_mfma_f32_32x32x16_bf16 v[120:135], v[224:227], v[64:67], v[120:135]
    ds_write_b128 v6, v[104:107] offset:0
    ds_write_b128 v6, v[108:111] offset:1024
    v_cvt_pk_bf16_f32 v70, v212, v213
    v_cvt_pk_bf16_f32 v71, v214, v215
    v_exp_f32 v184, v184
    v_exp_f32 v185, v185
    v_mfma_f32_32x32x16_bf16 v[120:135], v[228:231], v[68:71], v[120:135]
    ds_write_b128 v6, v[112:115] offset:2048
    ds_write_b128 v6, v[116:119] offset:3072
    s_mov_b64 exec, 1
    ds_add_u32 v13, v12 offset:4
    s_mov_b64 exec, -1
    v_exp_f32 v186, v186
    v_cvt_pk_bf16_f32 v64, v184, v185
    v_exp_f32 v187, v187
    v_exp_f32 v188, v188
    v_cvt_pk_bf16_f32 v65, v186, v187
    v_exp_f32 v189, v189
    v_exp_f32 v190, v190
    v_mfma_f32_32x32x16_bf16 v[200:215], v[16:19], v[160:163], 0
    v_cvt_pk_bf16_f32 v66, v188, v189
    v_exp_f32 v191, v191
    v_exp_f32 v192, v192
    v_cvt_pk_bf16_f32 v67, v190, v191
    v_mfma_f32_32x32x16_bf16 v[200:215], v[20:23], v[164:167], v[200:215]
    v_exp_f32 v193, v193
    v_exp_f32 v194, v194
    v_cvt_pk_bf16_f32 v68, v192, v193
    v_exp_f32 v195, v195
    v_exp_f32 v196, v196
    v_cvt_pk_bf16_f32 v69, v194, v195
    v_exp_f32 v197, v197
    v_exp_f32 v198, v198
    v_exp_f32 v199, v199
    v_mfma_f32_32x32x16_bf16 v[120:135], v[240:243], v[64:67], v[120:135]
    ds_read_b32 v8, v13 offset:4
    v_cvt_pk_bf16_f32 v70, v196, v197
    v_cvt_pk_bf16_f32 v71, v198, v199
    s_waitcnt lgkmcnt(0)
    v_readfirstlane_b32 s70, v8
    s_cmp_ge_u32 s70, 8
    s_cbranch_scc0 SL19
SL19B:
    v_exp_f32 v200, v200
    v_exp_f32 v201, v201
    v_mfma_f32_32x32x16_bf16 v[120:135], v[244:247], v[68:71], v[120:135]
    ds_read_b128 v[72:75], v7 offset:0
    ds_read_b128 v[76:79], v7 offset:1024
    ds_read_b128 v[80:83], v7 offset:2048
    v_exp_f32 v202, v202
    v_cvt_pk_bf16_f32 v64, v200, v201
    v_exp_f32 v203, v203
    v_exp_f32 v204, v204
    v_cvt_pk_bf16_f32 v65, v202, v203
    v_exp_f32 v205, v205
    v_exp_f32 v206, v206
    v_mfma_f32_32x32x16_bf16 v[184:199], v[32:35], v[160:163], 0
    ds_read_b128 v[84:87], v7 offset:3072
    ds_read_b128 v[88:91], v7 offset:4096
    ds_read_b128 v[92:95], v7 offset:5120
    v_cvt_pk_bf16_f32 v66, v204, v205
    v_exp_f32 v207, v207
    v_exp_f32 v208, v208
    v_cvt_pk_bf16_f32 v67, v206, v207
    v_mfma_f32_32x32x16_bf16 v[184:199], v[36:39], v[164:167], v[184:199]
    ds_read_b128 v[96:99], v7 offset:6144
    ds_read_b128 v[100:103], v7 offset:7168
    ds_read_b128 v[104:107], v7 offset:8192
    v_exp_f32 v209, v209
    v_exp_f32 v210, v210
    v_cvt_pk_bf16_f32 v68, v208, v209
    v_exp_f32 v211, v211
    v_exp_f32 v212, v212
    v_cvt_pk_bf16_f32 v69, v210, v211
    v_exp_f32 v213, v213
    v_exp_f32 v214, v214
    v_exp_f32 v215, v215
    v_mfma_f32_32x32x16_bf16 v[120:135], v[24:27], v[64:67], v[120:135]
    ds_read_b128 v[108:111], v7 offset:9216
    ds_read_b128 v[112:115], v7 offset:10240
    ds_read_b128 v[116:119], v7 offset:11264
    v_cvt_pk_bf16_f32 v70, v212, v213
    v_cvt_pk_bf16_f32 v71, v214, v215
    v_exp_f32 v184, v184
    v_exp_f32 v185, v185
    v_mfma_f32_32x32x16_bf16 v[120:135], v[28:31], v[68:71], v[120:135]
    s_waitcnt lgkmcnt(7)
    v_pk_add_f32 v[72:73], v[72:73], v[88:89]
    v_pk_add_f32 v[74:75], v[74:75], v[90:91]
    s_waitcnt lgkmcnt(6)
    v_pk_add_f32 v[76:77], v[76:77], v[92:93]
    v_pk_add_f32 v[78:79], v[78:79], v[94:95]
    v_exp_f32 v186, v186
    v_cvt_pk_bf16_f32 v64, v184, v185
    v_exp_f32 v187, v187
    v_exp_f32 v188, v188
    v_cvt_pk_bf16_f32 v65, v186, v187
    v_exp_f32 v189, v189
    v_exp_f32 v190, v190
    s_waitcnt lgkmcnt(5)
    v_pk_add_f32 v[80:81], v[80:81], v[96:97]
    v_pk_add_f32 v[82:83], v[82:83], v[98:99]
    s_waitcnt lgkmcnt(4)
    v_pk_add_f32 v[84:85], v[84:85], v[100:101]
    v_pk_add_f32 v[86:87], v[86:87], v[102:103]
    v_cvt_pk_bf16_f32 v66, v188, v189
    v_exp_f32 v191, v191
    v_exp_f32 v192, v192
    v_cvt_pk_bf16_f32 v67, v190, v191
    s_waitcnt lgkmcnt(3)
    v_pk_add_f32 v[72:73], v[72:73], v[104:105]
    v_pk_add_f32 v[74:75], v[74:75], v[106:107]
    s_waitcnt lgkmcnt(2)
    v_pk_add_f32 v[76:77], v[76:77], v[108:109]
    v_pk_add_f32 v[78:79], v[78:79], v[110:111]
    v_exp_f32 v193, v193
    v_exp_f32 v194, v194
    v_cvt_pk_bf16_f32 v68, v192, v193
    v_exp_f32 v195, v195
    v_exp_f32 v196, v196
    v_cvt_pk_bf16_f32 v69, v194, v195
    v_exp_f32 v197, v197
    v_exp_f32 v198, v198
    v_exp_f32 v199, v199
    v_mfma_f32_32x32x16_bf16 v[120:135], v[40:43], v[64:67], v[120:135]
    s_waitcnt lgkmcnt(1)
    v_pk_add_f32 v[80:81], v[80:81], v[112:113]
    v_pk_add_f32 v[82:83], v[82:83], v[114:115]
    s_waitcnt lgkmcnt(0)
    v_pk_add_f32 v[84:85], v[84:85], v[116:117]
    v_pk_add_f32 v[86:87], v[86:87], v[118:119]
    v_cvt_pk_bf16_f32 v70, v196, v197
    v_cvt_pk_bf16_f32 v71, v198, v199
    v_mov_b64 v[6:7], 0
    s_nop 0
    v_mfma_f32_32x32x16_bf16 v[120:135], v[44:47], v[68:71], v[120:135]
    s_lshl_b32 s67, s60, 2
    s_add_u32 s67, s67, s62
    s_mul_i32 s67, s67, 72
    s_cmp_ge_u32 s61, 7
    s_addc_u32 s68, s61, 0
    s_cmp_eq_u32 s61, 14
    s_cselect_b32 s68, 7, s68
    s_min_u32 s68, s68, 15
    s_add_u32 s67, s67, s68
    s_add_u32 s67, s67, 56
    s_lshl_b32 s67, s67, 11
    s_add_u32 s67, s67, 1048576
    s_nop 1
    v_pk_add_f32 v[120:121], v[120:121], v[72:73]
    v_pk_add_f32 v[122:123], v[122:123], v[74:75]
    v_pk_add_f32 v[124:125], v[124:125], v[76:77]
    v_pk_add_f32 v[126:127], v[126:127], v[78:79]
    v_pk_add_f32 v[128:129], v[128:129], v[80:81]
    v_pk_add_f32 v[130:131], v[130:131], v[82:83]
    v_pk_add_f32 v[132:133], v[132:133], v[84:85]
    v_pk_add_f32 v[134:135], v[134:135], v[86:87]
    v_mov_b32 v8, v132
    v_mov_b32 v9, v132
    v_pk_fma_f32 v[6:7], v[120:121], 0, v[6:7] op_sel_hi:[1,0,1]
    v_pk_fma_f32 v[6:7], v[122:123], 0, v[6:7] op_sel_hi:[1,0,1]
    v_permlane32_swap_b32 v8, v9
    v_pk_fma_f32 v[6:7], v[124:125], 0, v[6:7] op_sel_hi:[1,0,1]
    v_pk_fma_f32 v[6:7], v[126:127], 0, v[6:7] op_sel_hi:[1,0,1]
    v_pk_fma_f32 v[6:7], v[128:129], 0, v[6:7] op_sel_hi:[1,0,1]
    v_pk_fma_f32 v[6:7], v[130:131], 0, v[6:7] op_sel_hi:[1,0,1]
    v_pk_fma_f32 v[6:7], v[132:133], 0, v[6:7] op_sel_hi:[1,0,1]
    v_pk_fma_f32 v[6:7], v[134:135], 0, v[6:7] op_sel_hi:[1,0,1]
    v_add_f32 v6, v6, v7
    v_mov_b32 v7, 0x6c800000
    v_add_f32 v6, v6, v9
    v_cmp_le_f32 vcc, 0x2b800000, v6
    v_cmp_le_f32 s[70:71], v6, v7
    s_and_b64 vcc, vcc, s[70:71]
    s_cmp_eq_u64 vcc, exec
    s_cbranch_scc0 ATT_SLOW
ATT_FIN:
    v_rcp_f32 v9, v9
    s_nop 0
    v_mul_f32 v8, v9, v14
    v_pk_mul_f32 v[120:121], v[120:121], v[8:9] op_sel_hi:[1,0]
    v_pk_mul_f32 v[122:123], v[122:123], v[8:9] op_sel_hi:[1,0]
    v_pk_mul_f32 v[124:125], v[124:125], v[8:9] op_sel_hi:[1,0]
    v_pk_mul_f32 v[126:127], v[126:127], v[8:9] op_sel_hi:[1,0]
    v_cvt_pk_bf16_f32 v64, v120, v121
    v_cvt_pk_bf16_f32 v65, v122, v123
    v_cvt_pk_bf16_f32 v66, v124, v125
    v_cvt_pk_bf16_f32 v67, v126, v127
    v_min_u32 v64, -2, v64
    v_min_u32 v65, -2, v65
    v_min_u32 v66, -2, v66
    v_min_u32 v67, -2, v67
    buffer_store_dwordx4 v[64:67], v1, s[48:51], s67 offen offset:0 sc1
    v_pk_mul_f32 v[128:129], v[128:129], v[8:9] op_sel_hi:[1,0]
    v_pk_mul_f32 v[130:131], v[130:131], v[8:9] op_sel_hi:[1,0]
    v_pk_mul_f32 v[132:133], v[132:133], v[8:9] op_sel_hi:[1,0]
    v_pk_mul_f32 v[134:135], v[134:135], v[8:9] op_sel_hi:[1,0]
    v_cvt_pk_bf16_f32 v68, v128, v129
    v_cvt_pk_bf16_f32 v69, v130, v131
    v_cvt_pk_bf16_f32 v70, v132, v133
    v_cvt_pk_bf16_f32 v71, v134, v135
    v_cndmask_b32 v70, 0, v70, s[78:79]
    v_cndmask_b32 v71, 0, v71, s[78:79]
    v_min_u32 v68, -2, v68
    v_min_u32 v69, -2, v69
    v_min_u32 v70, -2, v70
    v_min_u32 v71, -2, v71
    buffer_store_dwordx4 v[68:71], v1, s[48:51], s67 offen offset:1024 sc1
    s_mov_b64 exec, 1
    ds_add_u32 v13, v12 offset:12
    s_mov_b64 exec, -1
EXIT:
    s_endpgm
ATT_SLOW:
    s_mov_b32 s73, 0
    v_mov_b32 v6, 0xff800000
ATT_S1:
    buffer_load_dwordx4 v[216:219], v1, s[48:51], s73 offen sc1
    buffer_load_dwordx4 v[220:223], v1, s[48:51], s73 offen offset:1024 sc1
    s_waitcnt vmcnt(0)
    v_mfma_f32_32x32x16_bf16 v[200:215], v[216:219], v[160:163], 0
    v_mfma_f32_32x32x16_bf16 v[200:215], v[220:223], v[164:167], v[200:215]
    s_nop 15
    v_max3_f32 v6, v6, v200, v201
    v_max3_f32 v6, v6, v202, v203
    v_max3_f32 v6, v6, v204, v205
    v_max3_f32 v6, v6, v206, v207
    v_max3_f32 v6, v6, v208, v209
    v_max3_f32 v6, v6, v210, v211
    v_max3_f32 v6, v6, v212, v213
    v_max3_f32 v6, v6, v214, v215
    s_add_u32 s73, s73, 4096
    s_cmp_lt_u32 s73, 262144
    s_cbranch_scc1 ATT_S1
    v_mov_b32 v7, v6
    s_nop 1
    v_permlane32_swap_b32 v6, v7
    s_nop 1
    v_max_f32 v6, v6, v7
    v_sub_f32 v184, 0, v6
    v_sub_f32 v185, 0, v6
    v_sub_f32 v186, 0, v6
    v_sub_f32 v187, 0, v6
    v_sub_f32 v188, 0, v6
    v_sub_f32 v189, 0, v6
    v_sub_f32 v190, 0, v6
    v_sub_f32 v191, 0, v6
    v_sub_f32 v192, 0, v6
    v_sub_f32 v193, 0, v6
    v_sub_f32 v194, 0, v6
    v_sub_f32 v195, 0, v6
    v_sub_f32 v196, 0, v6
    v_sub_f32 v197, 0, v6
    v_sub_f32 v198, 0, v6
    v_sub_f32 v199, 0, v6
    v_mov_b32 v120, 0
    v_mov_b32 v121, 0
    v_mov_b32 v122, 0
    v_mov_b32 v123, 0
    v_mov_b32 v124, 0
    v_mov_b32 v125, 0
    v_mov_b32 v126, 0
    v_mov_b32 v127, 0
    v_mov_b32 v128, 0
    v_mov_b32 v129, 0
    v_mov_b32 v130, 0
    v_mov_b32 v131, 0
    v_mov_b32 v132, 0
    v_mov_b32 v133, 0
    v_mov_b32 v134, 0
    v_mov_b32 v135, 0
    s_mov_b32 s73, 0
ATT_S2:
    buffer_load_dwordx4 v[216:219], v1, s[48:51], s73 offen offset:0 sc1
    buffer_load_dwordx4 v[220:223], v1, s[48:51], s73 offen offset:1024 sc1
    buffer_load_dwordx4 v[224:227], v1, s[48:51], s73 offen offset:2048 sc1
    buffer_load_dwordx4 v[228:231], v1, s[48:51], s73 offen offset:3072 sc1
    s_waitcnt vmcnt(0)
    v_mfma_f32_32x32x16_bf16 v[200:215], v[216:219], v[160:163], v[184:199]
    v_mfma_f32_32x32x16_bf16 v[200:215], v[220:223], v[164:167], v[200:215]
    s_nop 15
    v_exp_f32 v200, v200
    v_exp_f32 v201, v201
    v_exp_f32 v202, v202
    v_exp_f32 v203, v203
    v_exp_f32 v204, v204
    v_exp_f32 v205, v205
    v_exp_f32 v206, v206
    v_exp_f32 v207, v207
    v_exp_f32 v208, v208
    v_exp_f32 v209, v209
    v_exp_f32 v210, v210
    v_exp_f32 v211, v211
    v_exp_f32 v212, v212
    v_exp_f32 v213, v213
    v_exp_f32 v214, v214
    v_exp_f32 v215, v215
    s_nop 0
    v_cvt_pk_bf16_f32 v64, v200, v201
    v_cvt_pk_bf16_f32 v65, v202, v203
    v_cvt_pk_bf16_f32 v66, v204, v205
    v_cvt_pk_bf16_f32 v67, v206, v207
    v_cvt_pk_bf16_f32 v68, v208, v209
    v_cvt_pk_bf16_f32 v69, v210, v211
    v_cvt_pk_bf16_f32 v70, v212, v213
    v_cvt_pk_bf16_f32 v71, v214, v215
    s_nop 1
    v_mfma_f32_32x32x16_bf16 v[120:135], v[224:227], v[64:67], v[120:135]
    v_mfma_f32_32x32x16_bf16 v[120:135], v[228:231], v[68:71], v[120:135]
    s_add_u32 s73, s73, 4096
    s_cmp_lt_u32 s73, 262144
    s_cbranch_scc1 ATT_S2
    s_nop 15
    v_mov_b32 v8, v132
    v_mov_b32 v9, v132
    s_nop 1
    v_permlane32_swap_b32 v8, v9
    s_nop 1
    s_branch ATT_FIN
A_SPARE:
    v_lshl_add_u32 v12, v12, 6, v15
    v_add_u32 v12, 114688, v12
    v_lshlrev_b32 v10, 4, v13
    v_add_u32 v10, 143360, v10
    v_mov_b32 v13, 159744
    v_add_u32 v6, 65536, v2
    v_add_u32 v7, 65536, v3
    v_add_u32 v8, 65536, v4
    v_add_u32 v9, 65536, v5
    s_lshl_b32 s67, s60, 2
    s_add_u32 s67, s67, s62
    s_mul_i32 s67, s67, 72
    s_cmp_ge_u32 s61, 7
    s_addc_u32 s68, s61, 0
    s_cmp_eq_u32 s61, 14
    s_cselect_b32 s68, 7, s68
    s_min_u32 s68, s68, 15
    s_add_u32 s67, s67, s68
    s_add_u32 s67, s67, 56
    s_lshl_b32 s67, s67, 11
    s_add_u32 s67, s67, 1048576
    v_mov_b32 v252, -1
    v_mov_b32 v253, -1
    v_mov_b32 v254, -1
    v_mov_b32 v255, -1
    buffer_store_dwordx4 v[252:255], v1, s[48:51], s67 offen sc1
    buffer_store_dwordx4 v[252:255], v1, s[48:51], s67 offen offset:1024 sc1
    v_mov_b64 v[72:73], 0
    v_mov_b64 v[74:75], 0
    v_mov_b64 v[76:77], 0
    v_mov_b64 v[78:79], 0
    v_mov_b64 v[80:81], 0
    v_mov_b64 v[82:83], 0
    v_mov_b64 v[84:85], 0
    v_mov_b64 v[86:87], 0
    v_mov_b64 v[88:89], 0
    v_mov_b64 v[90:91], 0
    v_mov_b64 v[92:93], 0
    v_mov_b64 v[94:95], 0
    v_mov_b64 v[96:97], 0
    v_mov_b64 v[98:99], 0
    v_mov_b64 v[100:101], 0
    v_mov_b64 v[102:103], 0
    v_mov_b64 v[104:105], 0
    v_mov_b64 v[106:107], 0
    v_mov_b64 v[108:109], 0
    v_mov_b64 v[110:111], 0
    v_mov_b64 v[112:113], 0
    v_mov_b64 v[114:115], 0
    v_mov_b64 v[116:117], 0
    v_mov_b64 v[118:119], 0
    v_mov_b64 v[120:121], 0
    v_mov_b64 v[122:123], 0
    v_mov_b64 v[124:125], 0
    v_mov_b64 v[126:127], 0
    v_mov_b64 v[128:129], 0
    v_mov_b64 v[130:131], 0
    v_mov_b64 v[132:133], 0
    v_mov_b64 v[134:135], 0
    s_lshl_b32 s68, s74, 12
    s_lshl_b32 s58, s74, 7
    s_lshl_b32 s67, s64, 13
    s_add_u32 s46, s67, s58
    s_add_u32 s46, s46, 278528
    s_mov_b32 s58, 256
    s_waitcnt lgkmcnt(0)
    s_barrier
    s_cmp_eq_u32 s64, 1
    s_cbranch_scc1 A_V
    ds_read_b128 v[16:19], v2 offset:0
    ds_read_b64_tr_b16 v[20:21], v12 offset:0
    ds_read_b64_tr_b16 v[22:23], v12 offset:256
    ds_read_b128 v[24:27], v10 offset:0
    ds_read_b128 v[28:31], v3 offset:0
    ds_read_b64_tr_b16 v[32:33], v12 offset:1024
    ds_read_b64_tr_b16 v[34:35], v12 offset:1280
    ds_read_b128 v[36:39], v10 offset:32
    ds_read_b128 v[40:43], v4 offset:0
    ds_read_b64_tr_b16 v[44:45], v12 offset:2048
    ds_read_b64_tr_b16 v[46:47], v12 offset:2304
    ds_read_b128 v[48:51], v10 offset:64
    ds_read_b128 v[52:55], v5 offset:0
    ds_read_b64_tr_b16 v[56:57], v12 offset:3072
    ds_read_b64_tr_b16 v[58:59], v12 offset:3328
    s_waitcnt lgkmcnt(14)
    ds_read_b128 v[60:63], v10 offset:96
    s_waitcnt lgkmcnt(13)
    v_mfma_f32_32x32x16_bf16 v[168:183], v[20:23], v[16:19], 0
    s_waitcnt lgkmcnt(12)
    v_mfma_f32_32x32x16_bf16 v[184:199], v[24:27], v[16:19], 0
    s_waitcnt lgkmcnt(9)
    v_mfma_f32_32x32x16_bf16 v[168:183], v[32:35], v[28:31], v[168:183]
    s_waitcnt lgkmcnt(8)
    v_mfma_f32_32x32x16_bf16 v[184:199], v[36:39], v[28:31], v[184:199]
    s_waitcnt lgkmcnt(5)
    v_mfma_f32_32x32x16_bf16 v[168:183], v[44:47], v[40:43], v[168:183]
    s_waitcnt lgkmcnt(0)
    v_mfma_f32_32x32x16_bf16 v[184:199], v[48:51], v[40:43], v[184:199]
    v_mfma_f32_32x32x16_bf16 v[168:183], v[56:59], v[52:55], v[168:183]
    v_mfma_f32_32x32x16_bf16 v[184:199], v[60:63], v[52:55], v[184:199]
    s_barrier
    ds_read_b128 v[16:19], v2 offset:16384
    ds_read_b64_tr_b16 v[20:21], v12 offset:4096
    ds_read_b64_tr_b16 v[22:23], v12 offset:4352
    ds_read_b128 v[24:27], v10 offset:128
    ds_read_b128 v[28:31], v3 offset:16384
    ds_read_b64_tr_b16 v[32:33], v12 offset:5120
    ds_read_b64_tr_b16 v[34:35], v12 offset:5376
    ds_read_b128 v[36:39], v10 offset:160
    ds_read_b128 v[40:43], v4 offset:16384
    ds_read_b64_tr_b16 v[44:45], v12 offset:6144
    ds_read_b64_tr_b16 v[46:47], v12 offset:6400
    ds_read_b128 v[48:51], v10 offset:192
    ds_read_b128 v[52:55], v5 offset:16384
    ds_read_b64_tr_b16 v[56:57], v12 offset:7168
    ds_read_b64_tr_b16 v[58:59], v12 offset:7424
    s_waitcnt lgkmcnt(14)
    ds_read_b128 v[60:63], v10 offset:224
    s_waitcnt lgkmcnt(13)
    v_mfma_f32_32x32x16_bf16 v[168:183], v[20:23], v[16:19], v[168:183]
    s_waitcnt lgkmcnt(12)
    v_mfma_f32_32x32x16_bf16 v[184:199], v[24:27], v[16:19], v[184:199]
    s_waitcnt lgkmcnt(9)
    v_mfma_f32_32x32x16_bf16 v[168:183], v[32:35], v[28:31], v[168:183]
    s_waitcnt lgkmcnt(8)
    v_mfma_f32_32x32x16_bf16 v[184:199], v[36:39], v[28:31], v[184:199]
    s_waitcnt lgkmcnt(5)
    v_mfma_f32_32x32x16_bf16 v[168:183], v[44:47], v[40:43], v[168:183]
    s_waitcnt lgkmcnt(0)
    v_mfma_f32_32x32x16_bf16 v[184:199], v[48:51], v[40:43], v[184:199]
    v_mfma_f32_32x32x16_bf16 v[168:183], v[56:59], v[52:55], v[168:183]
    v_mfma_f32_32x32x16_bf16 v[184:199], v[60:63], v[52:55], v[184:199]
    s_barrier
    ds_read_b128 v[16:19], v2 offset:32768
    ds_read_b64_tr_b16 v[20:21], v12 offset:8192
    ds_read_b64_tr_b16 v[22:23], v12 offset:8448
    ds_read_b128 v[24:27], v10 offset:256
    ds_read_b128 v[28:31], v3 offset:32768
    ds_read_b64_tr_b16 v[32:33], v12 offset:9216
    ds_read_b64_tr_b16 v[34:35], v12 offset:9472
    ds_read_b128 v[36:39], v10 offset:288
    ds_read_b128 v[40:43], v4 offset:32768
    ds_read_b64_tr_b16 v[44:45], v12 offset:10240
    ds_read_b64_tr_b16 v[46:47], v12 offset:10496
    ds_read_b128 v[48:51], v10 offset:320
    ds_read_b128 v[52:55], v5 offset:32768
    ds_read_b64_tr_b16 v[56:57], v12 offset:11264
    ds_read_b64_tr_b16 v[58:59], v12 offset:11520
    s_waitcnt lgkmcnt(14)
    ds_read_b128 v[60:63], v10 offset:352
    s_waitcnt lgkmcnt(13)
    v_mfma_f32_32x32x16_bf16 v[168:183], v[20:23], v[16:19], v[168:183]
    s_waitcnt lgkmcnt(12)
    v_mfma_f32_32x32x16_bf16 v[184:199], v[24:27], v[16:19], v[184:199]
    s_waitcnt lgkmcnt(9)
    v_mfma_f32_32x32x16_bf16 v[168:183], v[32:35], v[28:31], v[168:183]
    s_waitcnt lgkmcnt(8)
    v_mfma_f32_32x32x16_bf16 v[184:199], v[36:39], v[28:31], v[184:199]
    s_waitcnt lgkmcnt(5)
    v_mfma_f32_32x32x16_bf16 v[168:183], v[44:47], v[40:43], v[168:183]
    s_waitcnt lgkmcnt(0)
    v_mfma_f32_32x32x16_bf16 v[184:199], v[48:51], v[40:43], v[184:199]
    v_mfma_f32_32x32x16_bf16 v[168:183], v[56:59], v[52:55], v[168:183]
    v_mfma_f32_32x32x16_bf16 v[184:199], v[60:63], v[52:55], v[184:199]
    s_barrier
    buffer_load_dword v249, v248, s[56:59], 0 offen sc1
    ds_read_b128 v[16:19], v2 offset:49152
    ds_read_b64_tr_b16 v[20:21], v12 offset:12288
    ds_read_b64_tr_b16 v[22:23], v12 offset:12544
    ds_read_b128 v[24:27], v10 offset:384
    ds_read_b128 v[28:31], v3 offset:49152
    ds_read_b64_tr_b16 v[32:33], v12 offset:13312
    ds_read_b64_tr_b16 v[34:35], v12 offset:13568
    ds_read_b128 v[36:39], v10 offset:416
    ds_read_b128 v[40:43], v4 offset:49152
    ds_read_b64_tr_b16 v[44:45], v12 offset:14336
    ds_read_b64_tr_b16 v[46:47], v12 offset:14592
    ds_read_b128 v[48:51], v10 offset:448
    ds_read_b128 v[52:55], v5 offset:49152
    ds_read_b64_tr_b16 v[56:57], v12 offset:15360
    ds_read_b64_tr_b16 v[58:59], v12 offset:15616
    s_waitcnt lgkmcnt(14)
    ds_read_b128 v[60:63], v10 offset:480
    s_waitcnt lgkmcnt(13)
    v_mfma_f32_32x32x16_bf16 v[168:183], v[20:23], v[16:19], v[168:183]
    s_waitcnt lgkmcnt(12)
    v_mfma_f32_32x32x16_bf16 v[184:199], v[24:27], v[16:19], v[184:199]
    s_waitcnt lgkmcnt(9)
    v_mfma_f32_32x32x16_bf16 v[168:183], v[32:35], v[28:31], v[168:183]
    s_waitcnt lgkmcnt(8)
    v_mfma_f32_32x32x16_bf16 v[184:199], v[36:39], v[28:31], v[184:199]
    s_waitcnt lgkmcnt(5)
    v_mfma_f32_32x32x16_bf16 v[168:183], v[44:47], v[40:43], v[168:183]
    s_waitcnt lgkmcnt(0)
    v_mfma_f32_32x32x16_bf16 v[184:199], v[48:51], v[40:43], v[184:199]
    v_mfma_f32_32x32x16_bf16 v[168:183], v[56:59], v[52:55], v[168:183]
    v_mfma_f32_32x32x16_bf16 v[184:199], v[60:63], v[52:55], v[184:199]
    s_barrier
    ds_read_b128 v[16:19], v6 offset:0
    ds_read_b64_tr_b16 v[20:21], v12 offset:16384
    ds_read_b64_tr_b16 v[22:23], v12 offset:16640
    ds_read_b128 v[24:27], v10 offset:512
    ds_read_b128 v[28:31], v7 offset:0
    ds_read_b64_tr_b16 v[32:33], v12 offset:17408
    ds_read_b64_tr_b16 v[34:35], v12 offset:17664
    ds_read_b128 v[36:39], v10 offset:544
    ds_read_b128 v[40:43], v8 offset:0
    ds_read_b64_tr_b16 v[44:45], v12 offset:18432
    ds_read_b64_tr_b16 v[46:47], v12 offset:18688
    ds_read_b128 v[48:51], v10 offset:576
    ds_read_b128 v[52:55], v9 offset:0
    ds_read_b64_tr_b16 v[56:57], v12 offset:19456
    ds_read_b64_tr_b16 v[58:59], v12 offset:19712
    s_waitcnt lgkmcnt(14)
    ds_read_b128 v[60:63], v10 offset:608
    s_waitcnt lgkmcnt(13)
    v_mfma_f32_32x32x16_bf16 v[168:183], v[20:23], v[16:19], v[168:183]
    s_waitcnt lgkmcnt(12)
    v_mfma_f32_32x32x16_bf16 v[184:199], v[24:27], v[16:19], v[184:199]
    s_waitcnt lgkmcnt(9)
    v_mfma_f32_32x32x16_bf16 v[168:183], v[32:35], v[28:31], v[168:183]
    s_waitcnt lgkmcnt(8)
    v_mfma_f32_32x32x16_bf16 v[184:199], v[36:39], v[28:31], v[184:199]
    s_waitcnt lgkmcnt(5)
    v_mfma_f32_32x32x16_bf16 v[168:183], v[44:47], v[40:43], v[168:183]
    s_waitcnt lgkmcnt(0)
    v_mfma_f32_32x32x16_bf16 v[184:199], v[48:51], v[40:43], v[184:199]
    v_mfma_f32_32x32x16_bf16 v[168:183], v[56:59], v[52:55], v[168:183]
    v_mfma_f32_32x32x16_bf16 v[184:199], v[60:63], v[52:55], v[184:199]
    s_barrier
    ds_read_b128 v[16:19], v6 offset:16384
    ds_read_b64_tr_b16 v[20:21], v12 offset:20480
    ds_read_b64_tr_b16 v[22:23], v12 offset:20736
    ds_read_b128 v[24:27], v10 offset:640
    ds_read_b128 v[28:31], v7 offset:16384
    ds_read_b64_tr_b16 v[32:33], v12 offset:21504
    ds_read_b64_tr_b16 v[34:35], v12 offset:21760
    ds_read_b128 v[36:39], v10 offset:672
    ds_read_b128 v[40:43], v8 offset:16384
    ds_read_b64_tr_b16 v[44:45], v12 offset:22528
    ds_read_b64_tr_b16 v[46:47], v12 offset:22784
    ds_read_b128 v[48:51], v10 offset:704
    ds_read_b128 v[52:55], v9 offset:16384
    ds_read_b64_tr_b16 v[56:57], v12 offset:23552
    ds_read_b64_tr_b16 v[58:59], v12 offset:23808
    s_waitcnt lgkmcnt(14)
    ds_read_b128 v[60:63], v10 offset:736
    s_waitcnt lgkmcnt(13)
    v_mfma_f32_32x32x16_bf16 v[168:183], v[20:23], v[16:19], v[168:183]
    s_waitcnt lgkmcnt(12)
    v_mfma_f32_32x32x16_bf16 v[184:199], v[24:27], v[16:19], v[184:199]
    s_waitcnt lgkmcnt(9)
    v_mfma_f32_32x32x16_bf16 v[168:183], v[32:35], v[28:31], v[168:183]
    s_waitcnt lgkmcnt(8)
    v_mfma_f32_32x32x16_bf16 v[184:199], v[36:39], v[28:31], v[184:199]
    s_waitcnt lgkmcnt(5)
    v_mfma_f32_32x32x16_bf16 v[168:183], v[44:47], v[40:43], v[168:183]
    s_waitcnt lgkmcnt(0)
    v_mfma_f32_32x32x16_bf16 v[184:199], v[48:51], v[40:43], v[184:199]
    v_mfma_f32_32x32x16_bf16 v[168:183], v[56:59], v[52:55], v[168:183]
    v_mfma_f32_32x32x16_bf16 v[184:199], v[60:63], v[52:55], v[184:199]
    s_barrier
    ds_read_b128 v[16:19], v6 offset:32768
    ds_read_b64_tr_b16 v[20:21], v12 offset:24576
    ds_read_b64_tr_b16 v[22:23], v12 offset:24832
    ds_read_b128 v[24:27], v10 offset:768
    ds_read_b128 v[28:31], v7 offset:32768
    ds_read_b64_tr_b16 v[32:33], v12 offset:25600
    ds_read_b64_tr_b16 v[34:35], v12 offset:25856
    ds_read_b128 v[36:39], v10 offset:800
    ds_read_b128 v[40:43], v8 offset:32768
    ds_read_b64_tr_b16 v[44:45], v12 offset:26624
    ds_read_b64_tr_b16 v[46:47], v12 offset:26880
    ds_read_b128 v[48:51], v10 offset:832
    ds_read_b128 v[52:55], v9 offset:32768
    ds_read_b64_tr_b16 v[56:57], v12 offset:27648
    ds_read_b64_tr_b16 v[58:59], v12 offset:27904
    s_waitcnt lgkmcnt(14)
    ds_read_b128 v[60:63], v10 offset:864
    s_waitcnt lgkmcnt(13)
    v_mfma_f32_32x32x16_bf16 v[168:183], v[20:23], v[16:19], v[168:183]
    s_waitcnt lgkmcnt(12)
    v_mfma_f32_32x32x16_bf16 v[184:199], v[24:27], v[16:19], v[184:199]
    s_waitcnt lgkmcnt(9)
    v_mfma_f32_32x32x16_bf16 v[168:183], v[32:35], v[28:31], v[168:183]
    s_waitcnt lgkmcnt(8)
    v_mfma_f32_32x32x16_bf16 v[184:199], v[36:39], v[28:31], v[184:199]
    s_waitcnt lgkmcnt(5)
    v_mfma_f32_32x32x16_bf16 v[168:183], v[44:47], v[40:43], v[168:183]
    s_waitcnt lgkmcnt(0)
    v_mfma_f32_32x32x16_bf16 v[184:199], v[48:51], v[40:43], v[184:199]
    v_mfma_f32_32x32x16_bf16 v[168:183], v[56:59], v[52:55], v[168:183]
    v_mfma_f32_32x32x16_bf16 v[184:199], v[60:63], v[52:55], v[184:199]
    s_nop 7
    s_nop 2
    v_cvt_pk_bf16_f32 v56, v168, v169
    v_cvt_pk_bf16_f32 v57, v170, v171
    v_cvt_pk_bf16_f32 v58, v172, v173
    v_cvt_pk_bf16_f32 v59, v174, v175
    v_cvt_pk_bf16_f32 v60, v176, v177
    v_cvt_pk_bf16_f32 v61, v178, v179
    v_cvt_pk_bf16_f32 v62, v180, v181
    v_cvt_pk_bf16_f32 v63, v182, v183
    v_cndmask_b32 v62, 0, v62, s[78:79]
    v_cndmask_b32 v63, 0, v63, s[78:79]
    buffer_store_dwordx4 v[56:59], v1, s[48:51], s68 offen sc1
    buffer_store_dwordx4 v[60:63], v1, s[48:51], s68 offen offset:1024 sc1
    v_mul_f32 v64, 0xbfb8aa3b, v184
    v_exp_f32 v64, v64
    v_and_b32 v65, 31, v0
    v_add_f32 v64, 1.0, v64
    v_rcp_f32 v64, v64
    v_lshlrev_b32 v65, 2, v65
    s_mov_b64 exec, s[78:79]
    buffer_store_dword v64, v65, s[48:51], s69 offen sc1
    s_mov_b64 exec, -1
    s_branch A_SP2
A_V:
    ds_read_b128 v[16:19], v2 offset:0
    ds_read_b64_tr_b16 v[20:21], v12 offset:0
    ds_read_b64_tr_b16 v[22:23], v12 offset:256
    ds_read_b128 v[24:27], v3 offset:0
    ds_read_b64_tr_b16 v[28:29], v12 offset:1024
    ds_read_b64_tr_b16 v[30:31], v12 offset:1280
    ds_read_b128 v[32:35], v4 offset:0
    ds_read_b64_tr_b16 v[36:37], v12 offset:2048
    ds_read_b64_tr_b16 v[38:39], v12 offset:2304
    ds_read_b128 v[40:43], v5 offset:0
    ds_read_b64_tr_b16 v[44:45], v12 offset:3072
    ds_read_b64_tr_b16 v[46:47], v12 offset:3328
    s_waitcnt lgkmcnt(9)
    v_mfma_f32_32x32x16_bf16 v[168:183], v[16:19], v[20:23], 0
    s_waitcnt lgkmcnt(6)
    v_mfma_f32_32x32x16_bf16 v[168:183], v[24:27], v[28:31], v[168:183]
    s_waitcnt lgkmcnt(3)
    v_mfma_f32_32x32x16_bf16 v[168:183], v[32:35], v[36:39], v[168:183]
    s_waitcnt lgkmcnt(0)
    v_mfma_f32_32x32x16_bf16 v[168:183], v[40:43], v[44:47], v[168:183]
    s_barrier
    ds_read_b128 v[136:139], v2 offset:16384
    ds_read_b64_tr_b16 v[140:141], v12 offset:4096
    ds_read_b64_tr_b16 v[142:143], v12 offset:4352
    ds_read_b128 v[144:147], v3 offset:16384
    ds_read_b64_tr_b16 v[148:149], v12 offset:5120
    ds_read_b64_tr_b16 v[150:151], v12 offset:5376
    ds_read_b128 v[152:155], v4 offset:16384
    ds_read_b64_tr_b16 v[156:157], v12 offset:6144
    ds_read_b64_tr_b16 v[158:159], v12 offset:6400
    ds_read_b128 v[160:163], v5 offset:16384
    ds_read_b64_tr_b16 v[164:165], v12 offset:7168
    ds_read_b64_tr_b16 v[166:167], v12 offset:7424
    s_waitcnt lgkmcnt(9)
    v_mfma_f32_32x32x16_bf16 v[168:183], v[136:139], v[140:143], v[168:183]
    s_waitcnt lgkmcnt(6)
    v_mfma_f32_32x32x16_bf16 v[168:183], v[144:147], v[148:151], v[168:183]
    s_waitcnt lgkmcnt(3)
    v_mfma_f32_32x32x16_bf16 v[168:183], v[152:155], v[156:159], v[168:183]
    s_waitcnt lgkmcnt(0)
    v_mfma_f32_32x32x16_bf16 v[168:183], v[160:163], v[164:167], v[168:183]
    s_barrier
    ds_read_b128 v[16:19], v2 offset:32768
    ds_read_b64_tr_b16 v[20:21], v12 offset:8192
    ds_read_b64_tr_b16 v[22:23], v12 offset:8448
    ds_read_b128 v[24:27], v3 offset:32768
    ds_read_b64_tr_b16 v[28:29], v12 offset:9216
    ds_read_b64_tr_b16 v[30:31], v12 offset:9472
    ds_read_b128 v[32:35], v4 offset:32768
    ds_read_b64_tr_b16 v[36:37], v12 offset:10240
    ds_read_b64_tr_b16 v[38:39], v12 offset:10496
    ds_read_b128 v[40:43], v5 offset:32768
    ds_read_b64_tr_b16 v[44:45], v12 offset:11264
    ds_read_b64_tr_b16 v[46:47], v12 offset:11520
    s_waitcnt lgkmcnt(9)
    v_mfma_f32_32x32x16_bf16 v[168:183], v[16:19], v[20:23], v[168:183]
    s_waitcnt lgkmcnt(6)
    v_mfma_f32_32x32x16_bf16 v[168:183], v[24:27], v[28:31], v[168:183]
    s_waitcnt lgkmcnt(3)
    v_mfma_f32_32x32x16_bf16 v[168:183], v[32:35], v[36:39], v[168:183]
    s_waitcnt lgkmcnt(0)
    v_mfma_f32_32x32x16_bf16 v[168:183], v[40:43], v[44:47], v[168:183]
    s_barrier
    buffer_load_dword v249, v248, s[56:59], 0 offen sc1
    ds_read_b128 v[136:139], v2 offset:49152
    ds_read_b64_tr_b16 v[140:141], v12 offset:12288
    ds_read_b64_tr_b16 v[142:143], v12 offset:12544
    ds_read_b128 v[144:147], v3 offset:49152
    ds_read_b64_tr_b16 v[148:149], v12 offset:13312
    ds_read_b64_tr_b16 v[150:151], v12 offset:13568
    ds_read_b128 v[152:155], v4 offset:49152
    ds_read_b64_tr_b16 v[156:157], v12 offset:14336
    ds_read_b64_tr_b16 v[158:159], v12 offset:14592
    ds_read_b128 v[160:163], v5 offset:49152
    ds_read_b64_tr_b16 v[164:165], v12 offset:15360
    ds_read_b64_tr_b16 v[166:167], v12 offset:15616
    s_waitcnt lgkmcnt(9)
    v_mfma_f32_32x32x16_bf16 v[168:183], v[136:139], v[140:143], v[168:183]
    s_waitcnt lgkmcnt(6)
    v_mfma_f32_32x32x16_bf16 v[168:183], v[144:147], v[148:151], v[168:183]
    s_waitcnt lgkmcnt(3)
    v_mfma_f32_32x32x16_bf16 v[168:183], v[152:155], v[156:159], v[168:183]
    s_waitcnt lgkmcnt(0)
    v_mfma_f32_32x32x16_bf16 v[168:183], v[160:163], v[164:167], v[168:183]
    s_barrier
    ds_read_b128 v[16:19], v6 offset:0
    ds_read_b64_tr_b16 v[20:21], v12 offset:16384
    ds_read_b64_tr_b16 v[22:23], v12 offset:16640
    ds_read_b128 v[24:27], v7 offset:0
    ds_read_b64_tr_b16 v[28:29], v12 offset:17408
    ds_read_b64_tr_b16 v[30:31], v12 offset:17664
    ds_read_b128 v[32:35], v8 offset:0
    ds_read_b64_tr_b16 v[36:37], v12 offset:18432
    ds_read_b64_tr_b16 v[38:39], v12 offset:18688
    ds_read_b128 v[40:43], v9 offset:0
    ds_read_b64_tr_b16 v[44:45], v12 offset:19456
    ds_read_b64_tr_b16 v[46:47], v12 offset:19712
    s_waitcnt lgkmcnt(9)
    v_mfma_f32_32x32x16_bf16 v[168:183], v[16:19], v[20:23], v[168:183]
    s_waitcnt lgkmcnt(6)
    v_mfma_f32_32x32x16_bf16 v[168:183], v[24:27], v[28:31], v[168:183]
    s_waitcnt lgkmcnt(3)
    v_mfma_f32_32x32x16_bf16 v[168:183], v[32:35], v[36:39], v[168:183]
    s_waitcnt lgkmcnt(0)
    v_mfma_f32_32x32x16_bf16 v[168:183], v[40:43], v[44:47], v[168:183]
    s_barrier
    ds_read_b128 v[136:139], v6 offset:16384
    ds_read_b64_tr_b16 v[140:141], v12 offset:20480
    ds_read_b64_tr_b16 v[142:143], v12 offset:20736
    ds_read_b128 v[144:147], v7 offset:16384
    ds_read_b64_tr_b16 v[148:149], v12 offset:21504
    ds_read_b64_tr_b16 v[150:151], v12 offset:21760
    ds_read_b128 v[152:155], v8 offset:16384
    ds_read_b64_tr_b16 v[156:157], v12 offset:22528
    ds_read_b64_tr_b16 v[158:159], v12 offset:22784
    ds_read_b128 v[160:163], v9 offset:16384
    ds_read_b64_tr_b16 v[164:165], v12 offset:23552
    ds_read_b64_tr_b16 v[166:167], v12 offset:23808
    s_waitcnt lgkmcnt(9)
    v_mfma_f32_32x32x16_bf16 v[168:183], v[136:139], v[140:143], v[168:183]
    s_waitcnt lgkmcnt(6)
    v_mfma_f32_32x32x16_bf16 v[168:183], v[144:147], v[148:151], v[168:183]
    s_waitcnt lgkmcnt(3)
    v_mfma_f32_32x32x16_bf16 v[168:183], v[152:155], v[156:159], v[168:183]
    s_waitcnt lgkmcnt(0)
    v_mfma_f32_32x32x16_bf16 v[168:183], v[160:163], v[164:167], v[168:183]
    s_barrier
    ds_read_b128 v[16:19], v6 offset:32768
    ds_read_b64_tr_b16 v[20:21], v12 offset:24576
    ds_read_b64_tr_b16 v[22:23], v12 offset:24832
    ds_read_b128 v[24:27], v7 offset:32768
    ds_read_b64_tr_b16 v[28:29], v12 offset:25600
    ds_read_b64_tr_b16 v[30:31], v12 offset:25856
    ds_read_b128 v[32:35], v8 offset:32768
    ds_read_b64_tr_b16 v[36:37], v12 offset:26624
    ds_read_b64_tr_b16 v[38:39], v12 offset:26880
    ds_read_b128 v[40:43], v9 offset:32768
    ds_read_b64_tr_b16 v[44:45], v12 offset:27648
    ds_read_b64_tr_b16 v[46:47], v12 offset:27904
    s_waitcnt lgkmcnt(9)
    v_mfma_f32_32x32x16_bf16 v[168:183], v[16:19], v[20:23], v[168:183]
    s_waitcnt lgkmcnt(6)
    v_mfma_f32_32x32x16_bf16 v[168:183], v[24:27], v[28:31], v[168:183]
    s_waitcnt lgkmcnt(3)
    v_mfma_f32_32x32x16_bf16 v[168:183], v[32:35], v[36:39], v[168:183]
    s_waitcnt lgkmcnt(0)
    v_mfma_f32_32x32x16_bf16 v[168:183], v[40:43], v[44:47], v[168:183]
    v_and_b32 v65, 31, v0
    v_cmp_gt_u32 vcc, 28, v65
    v_cmp_eq_u32 s[70:71], 28, v65
    v_mov_b32 v66, 0x3f803f80
    s_nop 7
    v_cndmask_b32 v66, 0, v66, s[70:71]
    v_cvt_pk_bf16_f32 v56, v168, v169
    v_cvt_pk_bf16_f32 v57, v170, v171
    v_cvt_pk_bf16_f32 v58, v172, v173
    v_cvt_pk_bf16_f32 v59, v174, v175
    v_cvt_pk_bf16_f32 v60, v176, v177
    v_cvt_pk_bf16_f32 v61, v178, v179
    v_cvt_pk_bf16_f32 v62, v180, v181
    v_cvt_pk_bf16_f32 v63, v182, v183
    v_cndmask_b32 v56, v66, v56, vcc
    v_cndmask_b32 v57, v66, v57, vcc
    v_cndmask_b32 v58, v66, v58, vcc
    v_cndmask_b32 v59, v66, v59, vcc
    v_cndmask_b32 v60, v66, v60, vcc
    v_cndmask_b32 v61, v66, v61, vcc
    v_cndmask_b32 v62, v66, v62, vcc
    v_cndmask_b32 v63, v66, v63, vcc
    buffer_store_dwordx4 v[56:59], v1, s[48:51], s68 offen offset:2048 sc1
    buffer_store_dwordx4 v[60:63], v1, s[48:51], s68 offen offset:3072 sc1
A_SP2:
    s_waitcnt vmcnt(0)
    v_readfirstlane_b32 s66, v249
    s_cmp_lg_u32 s66, 0
    s_cbranch_scc1 AS_HAVETAG
    s_mov_b32 s72, 65536
TAGS21:
    buffer_load_dword v249, v248, s[56:59], 0 offen sc1
    s_waitcnt vmcnt(0)
    v_readfirstlane_b32 s66, v249
    s_cmp_lg_u32 s66, 0
    s_cbranch_scc1 AS_HAVETAG
    s_sleep 2
    s_sub_u32 s72, s72, 1
    s_cmp_lg_u32 s72, 0
    s_cbranch_scc1 TAGS21
AS_HAVETAG:
    s_mov_b64 exec, 1
    buffer_store_dword v249, v248, s[48:51], s46 offen sc1
    s_mov_b64 exec, -1
    s_barrier
    s_barrier
    ds_read_b128 v[16:19], v2 offset:0
    ds_read_b64_tr_b16 v[20:21], v12 offset:0
    ds_read_b64_tr_b16 v[22:23], v12 offset:256
    ds_read_b128 v[24:27], v3 offset:0
    ds_read_b64_tr_b16 v[28:29], v12 offset:1024
    ds_read_b64_tr_b16 v[30:31], v12 offset:1280
    ds_read_b128 v[32:35], v4 offset:0
    ds_read_b64_tr_b16 v[36:37], v12 offset:2048
    ds_read_b64_tr_b16 v[38:39], v12 offset:2304
    ds_read_b128 v[40:43], v5 offset:0
    ds_read_b64_tr_b16 v[44:45], v12 offset:3072
    ds_read_b64_tr_b16 v[46:47], v12 offset:3328
    s_waitcnt lgkmcnt(9)
    v_mfma_f32_32x32x16_bf16 v[200:215], v[20:23], v[16:19], 0
    s_waitcnt lgkmcnt(6)
    v_mfma_f32_32x32x16_bf16 v[200:215], v[28:31], v[24:27], v[200:215]
    s_waitcnt lgkmcnt(3)
    v_mfma_f32_32x32x16_bf16 v[200:215], v[36:39], v[32:35], v[200:215]
    s_waitcnt lgkmcnt(0)
    v_mfma_f32_32x32x16_bf16 v[200:215], v[44:47], v[40:43], v[200:215]
    ds_read_b128 v[136:139], v2 offset:16384
    ds_read_b64_tr_b16 v[140:141], v12 offset:4096
    ds_read_b64_tr_b16 v[142:143], v12 offset:4352
    ds_read_b128 v[144:147], v3 offset:16384
    ds_read_b64_tr_b16 v[148:149], v12 offset:5120
    ds_read_b64_tr_b16 v[150:151], v12 offset:5376
    ds_read_b128 v[152:155], v4 offset:16384
    ds_read_b64_tr_b16 v[156:157], v12 offset:6144
    ds_read_b64_tr_b16 v[158:159], v12 offset:6400
    ds_read_b128 v[160:163], v5 offset:16384
    ds_read_b64_tr_b16 v[164:165], v12 offset:7168
    ds_read_b64_tr_b16 v[166:167], v12 offset:7424
    s_waitcnt lgkmcnt(9)
    v_mfma_f32_32x32x16_bf16 v[200:215], v[140:143], v[136:139], v[200:215]
    s_waitcnt lgkmcnt(6)
    v_mfma_f32_32x32x16_bf16 v[200:215], v[148:151], v[144:147], v[200:215]
    s_waitcnt lgkmcnt(3)
    v_mfma_f32_32x32x16_bf16 v[200:215], v[156:159], v[152:155], v[200:215]
    s_waitcnt lgkmcnt(0)
    v_mfma_f32_32x32x16_bf16 v[200:215], v[164:167], v[160:163], v[200:215]
    ds_read_b128 v[16:19], v2 offset:32768
    ds_read_b64_tr_b16 v[20:21], v12 offset:8192
    ds_read_b64_tr_b16 v[22:23], v12 offset:8448
    ds_read_b128 v[24:27], v3 offset:32768
    ds_read_b64_tr_b16 v[28:29], v12 offset:9216
    ds_read_b64_tr_b16 v[30:31], v12 offset:9472
    ds_read_b128 v[32:35], v4 offset:32768
    ds_read_b64_tr_b16 v[36:37], v12 offset:10240
    ds_read_b64_tr_b16 v[38:39], v12 offset:10496
    ds_read_b128 v[40:43], v5 offset:32768
    ds_read_b64_tr_b16 v[44:45], v12 offset:11264
    ds_read_b64_tr_b16 v[46:47], v12 offset:11520
    s_waitcnt lgkmcnt(9)
    v_mfma_f32_32x32x16_bf16 v[200:215], v[20:23], v[16:19], v[200:215]
    s_waitcnt lgkmcnt(6)
    v_mfma_f32_32x32x16_bf16 v[200:215], v[28:31], v[24:27], v[200:215]
    s_waitcnt lgkmcnt(3)
    v_mfma_f32_32x32x16_bf16 v[200:215], v[36:39], v[32:35], v[200:215]
    s_waitcnt lgkmcnt(0)
    v_mfma_f32_32x32x16_bf16 v[200:215], v[44:47], v[40:43], v[200:215]
    ds_read_b128 v[136:139], v2 offset:49152
    ds_read_b64_tr_b16 v[140:141], v12 offset:12288
    ds_read_b64_tr_b16 v[142:143], v12 offset:12544
    ds_read_b128 v[144:147], v3 offset:49152
    ds_read_b64_tr_b16 v[148:149], v12 offset:13312
    ds_read_b64_tr_b16 v[150:151], v12 offset:13568
    ds_read_b128 v[152:155], v4 offset:49152
    ds_read_b64_tr_b16 v[156:157], v12 offset:14336
    ds_read_b64_tr_b16 v[158:159], v12 offset:14592
    ds_read_b128 v[160:163], v5 offset:49152
    ds_read_b64_tr_b16 v[164:165], v12 offset:15360
    ds_read_b64_tr_b16 v[166:167], v12 offset:15616
    s_waitcnt lgkmcnt(9)
    v_mfma_f32_32x32x16_bf16 v[200:215], v[140:143], v[136:139], v[200:215]
    s_waitcnt lgkmcnt(6)
    v_mfma_f32_32x32x16_bf16 v[200:215], v[148:151], v[144:147], v[200:215]
    s_waitcnt lgkmcnt(3)
    v_mfma_f32_32x32x16_bf16 v[200:215], v[156:159], v[152:155], v[200:215]
    s_waitcnt lgkmcnt(0)
    v_mfma_f32_32x32x16_bf16 v[200:215], v[164:167], v[160:163], v[200:215]
    ds_read_b128 v[16:19], v6 offset:0
    ds_read_b64_tr_b16 v[20:21], v12 offset:16384
    ds_read_b64_tr_b16 v[22:23], v12 offset:16640
    ds_read_b128 v[24:27], v7 offset:0
    ds_read_b64_tr_b16 v[28:29], v12 offset:17408
    ds_read_b64_tr_b16 v[30:31], v12 offset:17664
    ds_read_b128 v[32:35], v8 offset:0
    ds_read_b64_tr_b16 v[36:37], v12 offset:18432
    ds_read_b64_tr_b16 v[38:39], v12 offset:18688
    ds_read_b128 v[40:43], v9 offset:0
    ds_read_b64_tr_b16 v[44:45], v12 offset:19456
    ds_read_b64_tr_b16 v[46:47], v12 offset:19712
    s_waitcnt lgkmcnt(9)
    v_mfma_f32_32x32x16_bf16 v[200:215], v[20:23], v[16:19], v[200:215]
    s_waitcnt lgkmcnt(6)
    v_mfma_f32_32x32x16_bf16 v[200:215], v[28:31], v[24:27], v[200:215]
    s_waitcnt lgkmcnt(3)
    v_mfma_f32_32x32x16_bf16 v[200:215], v[36:39], v[32:35], v[200:215]
    s_waitcnt lgkmcnt(0)
    v_mfma_f32_32x32x16_bf16 v[200:215], v[44:47], v[40:43], v[200:215]
    ds_read_b128 v[136:139], v6 offset:16384
    ds_read_b64_tr_b16 v[140:141], v12 offset:20480
    ds_read_b64_tr_b16 v[142:143], v12 offset:20736
    ds_read_b128 v[144:147], v7 offset:16384
    ds_read_b64_tr_b16 v[148:149], v12 offset:21504
    ds_read_b64_tr_b16 v[150:151], v12 offset:21760
    ds_read_b128 v[152:155], v8 offset:16384
    ds_read_b64_tr_b16 v[156:157], v12 offset:22528
    ds_read_b64_tr_b16 v[158:159], v12 offset:22784
    ds_read_b128 v[160:163], v9 offset:16384
    ds_read_b64_tr_b16 v[164:165], v12 offset:23552
    ds_read_b64_tr_b16 v[166:167], v12 offset:23808
    s_waitcnt lgkmcnt(9)
    v_mfma_f32_32x32x16_bf16 v[200:215], v[140:143], v[136:139], v[200:215]
    s_waitcnt lgkmcnt(6)
    v_mfma_f32_32x32x16_bf16 v[200:215], v[148:151], v[144:147], v[200:215]
    s_waitcnt lgkmcnt(3)
    v_mfma_f32_32x32x16_bf16 v[200:215], v[156:159], v[152:155], v[200:215]
    s_waitcnt lgkmcnt(0)
    v_mfma_f32_32x32x16_bf16 v[200:215], v[164:167], v[160:163], v[200:215]
    ds_read_b128 v[16:19], v6 offset:32768
    ds_read_b64_tr_b16 v[20:21], v12 offset:24576
    ds_read_b64_tr_b16 v[22:23], v12 offset:24832
    ds_read_b128 v[24:27], v7 offset:32768
    ds_read_b64_tr_b16 v[28:29], v12 offset:25600
    ds_read_b64_tr_b16 v[30:31], v12 offset:25856
    ds_read_b128 v[32:35], v8 offset:32768
    ds_read_b64_tr_b16 v[36:37], v12 offset:26624
    ds_read_b64_tr_b16 v[38:39], v12 offset:26880
    ds_read_b128 v[40:43], v9 offset:32768
    ds_read_b64_tr_b16 v[44:45], v12 offset:27648
    ds_read_b64_tr_b16 v[46:47], v12 offset:27904
    s_waitcnt lgkmcnt(9)
    v_mfma_f32_32x32x16_bf16 v[200:215], v[20:23], v[16:19], v[200:215]
    s_waitcnt lgkmcnt(6)
    v_mfma_f32_32x32x16_bf16 v[200:215], v[28:31], v[24:27], v[200:215]
    s_waitcnt lgkmcnt(3)
    v_mfma_f32_32x32x16_bf16 v[200:215], v[36:39], v[32:35], v[200:215]
    s_waitcnt lgkmcnt(0)
    v_mfma_f32_32x32x16_bf16 v[200:215], v[44:47], v[40:43], v[200:215]
    s_mov_b64 exec, s[44:45]
    buffer_load_dword v252, v250, s[48:51], 0 offen sc1
    s_mov_b64 exec, -1
    v_add_u32 v251, s75, v1
    v_mov_b32 v249, 1
    s_barrier
    s_mov_b32 s72, 65536
KVP22:
    s_waitcnt vmcnt(0)
    v_cmp_eq_u32 vcc, s66, v252
    s_and_b64 vcc, vcc, s[44:45]
    s_cmp_eq_u64 vcc, s[44:45]
    s_cbranch_scc1 KVP22D
    s_sleep 2
    s_mov_b64 exec, s[44:45]
    buffer_load_dword v252, v250, s[48:51], 0 offen sc1
    s_mov_b64 exec, -1
    s_sub_u32 s72, s72, 1
    s_cmp_lg_u32 s72, 0
    s_cbranch_scc1 KVP22
    s_waitcnt vmcnt(0)
KVP22D:
    buffer_load_dwordx4 v[216:219], v1, s[52:55], 0 offen offset:0 sc1
    buffer_load_dwordx4 v[220:223], v1, s[52:55], 0 offen offset:1024 sc1
    buffer_load_dwordx4 v[224:227], v1, s[52:55], 0 offen offset:2048 sc1
    buffer_load_dwordx4 v[228:231], v1, s[52:55], 0 offen offset:3072 sc1
    buffer_load_dwordx4 v[232:235], v1, s[52:55], s73 offen offset:0 sc1
    buffer_load_dwordx4 v[236:239], v1, s[52:55], s73 offen offset:1024 sc1
    buffer_load_dwordx4 v[240:243], v1, s[52:55], s73 offen offset:2048 sc1
    buffer_load_dwordx4 v[244:247], v1, s[52:55], s73 offen offset:3072 sc1
    v_and_b32 v15, 31, v0
    v_lshlrev_b32 v15, 2, v15
    buffer_load_dword v14, v15, s[48:51], s69 offen sc1
    s_movk_i32 s73, 8192
    v_pk_mul_f32 v[200:201], v[200:201], s[76:77]
    v_pk_mul_f32 v[202:203], v[202:203], s[76:77]
    v_pk_mul_f32 v[204:205], v[204:205], s[76:77]
    v_pk_mul_f32 v[206:207], v[206:207], s[76:77]
    v_pk_mul_f32 v[208:209], v[208:209], s[76:77]
    v_pk_mul_f32 v[210:211], v[210:211], s[76:77]
    v_pk_mul_f32 v[212:213], v[212:213], s[76:77]
    v_pk_mul_f32 v[214:215], v[214:215], s[76:77]
    v_cvt_pk_bf16_f32 v40, v200, v201
    v_cvt_pk_bf16_f32 v41, v202, v203
    v_cvt_pk_bf16_f32 v42, v204, v205
    v_cvt_pk_bf16_f32 v43, v206, v207
    v_cvt_pk_bf16_f32 v44, v208, v209
    v_cvt_pk_bf16_f32 v45, v210, v211
    v_cvt_pk_bf16_f32 v46, v212, v213
    v_cvt_pk_bf16_f32 v47, v214, v215
    v_cndmask_b32 v46, 0, v46, s[78:79]
    v_cndmask_b32 v47, 0, v47, s[78:79]
    ds_write_b128 v251, v[40:43] offset:10240
    ds_write_b128 v251, v[44:47] offset:11264
    s_mov_b64 exec, 1
    ds_add_u32 v13, v249 offset:4
    s_mov_b64 exec, -1
    s_mov_b32 s72, 1048576
LS23:
    ds_read_b32 v4, v13 offset:4
    s_waitcnt lgkmcnt(0)
    v_readfirstlane_b32 s70, v4
    s_cmp_ge_u32 s70, 4
    s_cbranch_scc1 LS23D
    s_sub_u32 s72, s72, 1
    s_cmp_lg_u32 s72, 0
    s_cbranch_scc1 LS23
LS23D:
    v_add_u32 v4, s80, v1
    v_add_u32 v5, s81, v1
    v_add_u32 v6, s82, v1
    v_add_u32 v7, s83, v1
    ds_read_b128 v[136:139], v4
    ds_read_b128 v[140:143], v4 offset:1024
    ds_read_b128 v[144:147], v5
    ds_read_b128 v[148:151], v5 offset:1024
    ds_read_b128 v[152:155], v6
    ds_read_b128 v[156:159], v6 offset:1024
    ds_read_b128 v[160:163], v7
    ds_read_b128 v[164:167], v7 offset:1024
    v_mov_b64 v[68:69], 0
    v_mov_b64 v[70:71], 0
    v_mov_b64 v[28:29], 0
    v_mov_b64 v[30:31], 0
    s_waitcnt vmcnt(5) lgkmcnt(0)
    v_mfma_f32_32x32x16_bf16 v[200:215], v[216:219], v[136:139], 0
    v_mfma_f32_32x32x16_bf16 v[200:215], v[220:223], v[140:143], v[200:215]
    s_nop 7
    s_nop 1
    s_branch ATT
SL6:
    s_mov_b32 s72, 65536
    s_mov_b64 exec, s[56:57]
POLL7:
    buffer_load_dword v13, v12, s[48:51], s53 offen sc1
    s_waitcnt vmcnt(0)
    v_cmp_eq_u32 vcc, s66, v13
    s_cmp_eq_u64 vcc, exec
    s_cbranch_scc1 POLL7D
    s_sleep 2
    s_sub_u32 s72, s72, 1
    s_cmp_lg_u32 s72, 0
    s_cbranch_scc1 POLL7
POLL7D:
    s_mov_b64 exec, -1
    s_branch SL6B
SL12:
    s_mov_b32 s72, 65536
TAGS14:
    buffer_load_dword v249, v248, s[56:59], 0 offen sc1
    s_waitcnt vmcnt(0)
    v_readfirstlane_b32 s66, v249
    s_cmp_lg_u32 s66, 0
    s_cbranch_scc1 HT13
    s_sleep 2
    s_sub_u32 s72, s72, 1
    s_cmp_lg_u32 s72, 0
    s_cbranch_scc1 TAGS14
HT13:
    s_branch SL12B
SL15:
    s_mov_b64 exec, s[44:45]
    buffer_load_dword v3, v2, s[48:51], 0 offen sc1
    s_mov_b64 exec, -1
    s_mov_b32 s72, 65536
KVP16:
    s_waitcnt vmcnt(0)
    v_cmp_eq_u32 vcc, s66, v3
    s_and_b64 vcc, vcc, s[44:45]
    s_cmp_eq_u64 vcc, s[44:45]
    s_cbranch_scc1 KVP16D
    s_sleep 2
    s_mov_b64 exec, s[44:45]
    buffer_load_dword v3, v2, s[48:51], 0 offen sc1
    s_mov_b64 exec, -1
    s_sub_u32 s72, s72, 1
    s_cmp_lg_u32 s72, 0
    s_cbranch_scc1 KVP16
    s_waitcnt vmcnt(0)
KVP16D:
    s_mov_b32 s54, 65536
    s_movk_i32 s73, 4096
    buffer_load_dwordx4 v[216:219], v1, s[52:55], 0 offen offset:0 sc1
    buffer_load_dwordx4 v[220:223], v1, s[52:55], 0 offen offset:1024 sc1
    buffer_load_dwordx4 v[224:227], v1, s[52:55], 0 offen offset:2048 sc1
    buffer_load_dwordx4 v[228:231], v1, s[52:55], 0 offen offset:3072 sc1
    buffer_load_dwordx4 v[232:235], v1, s[52:55], s73 offen offset:0 sc1
    buffer_load_dwordx4 v[236:239], v1, s[52:55], s73 offen offset:1024 sc1
    buffer_load_dwordx4 v[240:243], v1, s[52:55], s73 offen offset:2048 sc1
    buffer_load_dwordx4 v[244:247], v1, s[52:55], s73 offen offset:3072 sc1
    v_and_b32 v3, 31, v0
    v_lshlrev_b32 v3, 2, v3
    buffer_load_dword v14, v3, s[48:51], s69 offen sc1
    s_movk_i32 s73, 8192
    s_branch SL15B
SL17:
    s_mov_b32 s72, 1048576
LS18:
    ds_read_b32 v250, v13 offset:4
    s_waitcnt lgkmcnt(0)
    v_readfirstlane_b32 s70, v250
    s_cmp_ge_u32 s70, 4
    s_cbranch_scc1 LS18D
    s_sub_u32 s72, s72, 1
    s_cmp_lg_u32 s72, 0
    s_cbranch_scc1 LS18
LS18D:
    s_branch SL17B
SL19:
    s_mov_b32 s72, 1048576
LS20:
    ds_read_b32 v8, v13 offset:4
    s_waitcnt lgkmcnt(0)
    v_readfirstlane_b32 s70, v8
    s_cmp_ge_u32 s70, 8
    s_cbranch_scc1 LS20D
    s_sub_u32 s72, s72, 1
    s_cmp_lg_u32 s72, 0
    s_cbranch_scc1 LS20
LS20D:
    s_branch SL19B
KEND:
.section .rodata,"a"
.p2align 6
.amdhsa_kernel gated_mix__grouped_kv_mqa__glu_gated_bilinear__prompt_kernel
  .amdhsa_next_free_vgpr 256
  .amdhsa_next_free_sgpr 102
  .amdhsa_accum_offset 256
  .amdhsa_group_segment_fixed_size 0
  .amdhsa_kernarg_size 104
  .amdhsa_user_sgpr_count 2
  .amdhsa_user_sgpr_kernarg_segment_ptr 1
  .amdhsa_system_sgpr_workgroup_id_x 1
.end_amdhsa_kernel
```
